```python
import torch

def _softmax(x, axis=-1):
    return torch.softmax(x, dim=axis)
def _gelu(x):
    return torch.nn.functional.gelu(x, approximate="tanh")
def _silu(x):
    return torch.nn.functional.silu(x)
def _sigmoid(x):
    return torch.sigmoid(x)
def _layernorm(x, axis=-1, eps=1e-5):
    m = x.mean(dim=axis, keepdim=True)
    v = x.var(dim=axis, keepdim=True, unbiased=False)
    return (x - m) / torch.sqrt(v + eps)
def _scatter_add(tgt, idx, src, axis=0):
    return tgt.clone().index_add_(axis, idx, src)
def _segment_sum(src, seg, n):
    out = torch.zeros((n,) + src.shape[1:], dtype=src.dtype)
    return out.index_add_(0, seg, src)
def _pad(x, pw):
    flat = tuple(v for pair in reversed(pw) for v in pair)
    return torch.nn.functional.pad(x, flat)

kernel_name = 'parallel_sum__mha_block_cached__geglu_ffn__decode'

def setup_inputs():

    _w = (lambda a: (lambda t: t.to(torch.bfloat16) if t.is_floating_point() else t)(torch.as_tensor(a)))
    def _A_setup():
        B, Sq, D = 1, 1, 448
        H, Sk, Dh = 16, 32768, 256
        return {
            "x": _w((lambda *s: torch.randn(*s, dtype=torch.bfloat16) * 0.05)(B, Sq, D)),
            "k_cache": _w((lambda *s: torch.randn(*s, dtype=torch.bfloat16) * 3.2)(B, H, Sk, Dh)),
            "v_cache": _w((lambda *s: torch.randn(*s, dtype=torch.bfloat16) * 1.6)(B, H, Sk, Dh)),
            "wq": _w((lambda *s: torch.randn(*s, dtype=torch.bfloat16) * 3.2)(D, H * Dh) * (D ** -0.5)),
            "wo": _w((lambda *s: torch.randn(*s, dtype=torch.bfloat16) * 1.6)(H * Dh, D) * ((H * Dh) ** -0.5)),
        }
    _A_in = _A_setup()

    def _B_setup():
        B, S, D, F = 1, 1, 448, 1792
        return {
            "x": _w((lambda *s: torch.randn(*s, dtype=torch.bfloat16) * 0.05)(B, S, D)),
            "w_gate": _w((lambda *s: torch.randn(*s, dtype=torch.bfloat16) * 0.05)(D, F)),
            "w_up": _w((lambda *s: torch.randn(*s, dtype=torch.bfloat16) * 0.05)(D, F)),
            "w_down": _w((lambda *s: torch.randn(*s, dtype=torch.bfloat16) * 0.05)(F, D)),
        }
    _B_in = _B_setup()

    return {
        "A_x": _A_in["x"],
        "A_k_cache": _A_in["k_cache"],
        "A_v_cache": _A_in["v_cache"],
        "A_wq": _A_in["wq"],
        "A_wo": _A_in["wo"],
        "B_x": _B_in["x"],
        "B_w_gate": _B_in["w_gate"],
        "B_w_up": _B_in["w_up"],
        "B_w_down": _B_in["w_down"],
    }

def reference(A_x, A_k_cache, A_v_cache, A_wq, A_wo, B_x, B_w_gate, B_w_up, B_w_down):
    def _A_ref(x, k_cache, v_cache, wq, wo):
        B, Sq, D = x.shape
        H, Dh = 16, 256
        q = (lambda x, *d: x.permute(*d))((x @ wq).reshape(B, Sq, H, Dh), 0, 2, 1, 3)
        scores = torch.einsum("bhqd,bhkd->bhqk", q, k_cache) * (Dh ** -0.5)
        p = _softmax(scores, axis=-1)
        o = torch.einsum("bhqk,bhkd->bhqd", p, v_cache)
        return (lambda x, *d: x.permute(*d))(o, 0, 2, 1, 3).reshape(B, Sq, H * Dh) @ wo

    def _B_ref(x, w_gate, w_up, w_down):
        return (_gelu(x @ w_gate) * (x @ w_up)) @ w_down

    x = A_x
    xn = _layernorm(x, axis=-1)
    return x + _A_ref(xn, A_k_cache, A_v_cache, A_wq, A_wo) + _B_ref(xn, B_w_gate, B_w_up, B_w_down)
```

```asm
; @launch grid=(256,1,1) block=(320,1,1) lds=11520
.amdgcn_target "amdgcn-amd-amdhsa--gfx950"
.text
.globl parallel_sum__mha_block_cached__geglu_ffn__decode_kernel
.p2align 8
.type parallel_sum__mha_block_cached__geglu_ffn__decode_kernel,@function
parallel_sum__mha_block_cached__geglu_ffn__decode_kernel:
s_cmp_ge_u32 s2, 256
s_cbranch_scc1 L_end
s_load_dwordx16 s[4:19], s[0:1], 0
s_load_dwordx8 s[20:27], s[0:1], 64
v_lshrrev_b32 v1, 6, v0
v_and_b32 v0, 63, v0
v_readfirstlane_b32 s3, v1
s_lshr_b32 s60, s2, 4
s_and_b32 s61, s2, 15
s_mov_b32 s40, 0x3db8aa3b
s_cmp_eq_u32 s3, 4
s_cbranch_scc1 L_helper
v_and_b32 v1, 7, v0
v_lshlrev_b32 v1, 9, v1
v_bfe_u32 v2, v0, 3, 1
v_lshl_add_u32 v1, v2, 6, v1
v_lshrrev_b32 v3, 4, v0
v_lshl_add_u32 v1, v3, 4, v1
s_lshl_b32 s41, s60, 24
s_lshl_b32 s43, s3, 12
s_add_u32 s41, s41, s43
s_and_b32 s39, s61, 7
s_lshl_b32 s39, s39, 21
s_add_u32 s39, s39, s41
s_lshr_b32 s43, s61, 3
s_lshl_b32 s43, s43, 15
s_add_u32 s39, s39, s43
s_mov_b32 s36, s39
s_waitcnt lgkmcnt(0)
s_mov_b32 s28, s6
s_mov_b32 s29, s7
s_mov_b32 s30, 0x10000000
s_mov_b32 s31, 0x00020000
buffer_load_dwordx4 v[56:59], v1, s[28:31], s36 offen offset:0 nt
buffer_load_dwordx4 v[60:63], v1, s[28:31], s36 offen offset:128 nt
buffer_load_dwordx4 v[64:67], v1, s[28:31], s36 offen offset:256 nt
buffer_load_dwordx4 v[68:71], v1, s[28:31], s36 offen offset:384 nt
s_add_u32 s36, s36, 16384
s_mov_b32 s32, s8
s_mov_b32 s33, s9
s_mov_b32 s34, 0x10000000
s_mov_b32 s35, 0x00020000
s_mov_b32 s48, s26
s_mov_b32 s49, s27
s_mov_b32 s50, 0x120000
s_mov_b32 s51, 0x00020000
s_add_u32 s41, s41, 1835008
s_mul_i32 s52, s60, 8192
s_lshl_b32 s43, s3, 4
s_add_u32 s52, s52, s43
s_add_u32 s52, s52, 851968
v_bfe_u32 v2, v0, 4, 1
v_lshlrev_b32 v2, 11, v2
v_lshrrev_b32 v3, 5, v0
v_lshl_add_u32 v2, v3, 9, v2
v_and_b32 v3, 15, v0
v_lshl_add_u32 v2, v3, 4, v2
v_and_b32 v50, 1, v0
v_cmp_eq_u32 vcc, 1, v50
v_mov_b32 v50, 0xffff
v_mov_b32 v51, 0xffff0000
v_cndmask_b32 v50, v50, v51, vcc
v_bfe_u32 v51, v0, 1, 2
v_cmp_eq_u32 vcc, 0, v51
s_nop 1
v_cndmask_b32 v4, 0, v50, vcc
v_cmp_eq_u32 vcc, 1, v51
s_nop 1
v_cndmask_b32 v5, 0, v50, vcc
v_cmp_eq_u32 vcc, 2, v51
s_nop 1
v_cndmask_b32 v6, 0, v50, vcc
v_cmp_eq_u32 vcc, 3, v51
s_nop 1
v_cndmask_b32 v7, 0, v50, vcc
v_and_b32 v50, 8, v0
v_cmp_eq_u32 vcc, 8, v50
s_nop 1
v_cndmask_b32 v8, 0, 1.0, vcc
v_mov_b32 v9, 0xff7fffff
v_mov_b32 v16, 0
v_mov_b32 v17, 0
v_mov_b32 v18, 0
v_mov_b32 v19, 0
v_mov_b32 v20, 0
v_mov_b32 v21, 0
v_mov_b32 v22, 0
v_mov_b32 v23, 0
v_and_b32 v3, 1, v0
v_lshlrev_b32 v3, 6, v3
v_lshrrev_b32 v50, 4, v0
v_lshl_add_u32 v3, v50, 4, v3
v_lshlrev_b32 v53, 2, v50
s_lshl_b32 s43, s3, 10
s_add_u32 s53, s43, 5120
v_add_u32 v11, s53, v53
s_mov_b32 s44, 0x00010001
s_mov_b32 s45, 0x00010001
s_barrier
buffer_load_dwordx4 v[72:75], v1, s[28:31], s36 offen offset:0 nt
buffer_load_dwordx4 v[76:79], v1, s[28:31], s36 offen offset:128 nt
s_add_u32 s36, s36, 49152
s_waitcnt vmcnt(4)
buffer_load_dwordx4 v[88:91], v1, s[28:31], s36 offen offset:0 nt
buffer_load_dwordx4 v[92:95], v1, s[28:31], s36 offen offset:128 nt
s_waitcnt vmcnt(4)
buffer_load_dwordx4 v[96:99], v1, s[28:31], s36 offen offset:256 nt
buffer_load_dwordx4 v[100:103], v1, s[28:31], s36 offen offset:384 nt
s_add_u32 s36, s36, 16384
s_waitcnt vmcnt(4)
buffer_load_dwordx4 v[104:107], v1, s[28:31], s36 offen offset:0 nt
buffer_load_dwordx4 v[108:111], v1, s[28:31], s36 offen offset:128 nt
s_waitcnt vmcnt(4)
buffer_load_dwordx4 v[112:115], v1, s[28:31], s36 offen offset:256 nt
buffer_load_dwordx4 v[116:119], v1, s[28:31], s36 offen offset:384 nt
s_add_u32 s36, s36, 49152
s_waitcnt vmcnt(4)
buffer_load_dwordx4 v[120:123], v1, s[28:31], s36 offen offset:0 nt
buffer_load_dwordx4 v[124:127], v1, s[28:31], s36 offen offset:128 nt
s_waitcnt vmcnt(4)
buffer_load_dwordx4 v[128:131], v1, s[28:31], s36 offen offset:256 nt
buffer_load_dwordx4 v[132:135], v1, s[28:31], s36 offen offset:384 nt
s_add_u32 s36, s36, 16384
s_waitcnt vmcnt(4)
buffer_load_dwordx4 v[136:139], v1, s[28:31], s36 offen offset:0 nt
buffer_load_dwordx4 v[140:143], v1, s[28:31], s36 offen offset:128 nt
s_waitcnt vmcnt(4)
buffer_load_dwordx4 v[144:147], v1, s[28:31], s36 offen offset:256 nt
buffer_load_dwordx4 v[148:151], v1, s[28:31], s36 offen offset:384 nt
s_add_u32 s36, s36, 49152
s_waitcnt vmcnt(4)
buffer_load_dwordx4 v[152:155], v1, s[28:31], s36 offen offset:0 nt
buffer_load_dwordx4 v[156:159], v1, s[28:31], s36 offen offset:128 nt
s_waitcnt vmcnt(4)
buffer_load_dwordx4 v[160:163], v1, s[28:31], s36 offen offset:256 nt
buffer_load_dwordx4 v[164:167], v1, s[28:31], s36 offen offset:384 nt
s_add_u32 s36, s36, 16384
s_waitcnt vmcnt(4)
buffer_load_dwordx4 v[168:171], v1, s[28:31], s36 offen offset:0 nt
buffer_load_dwordx4 v[172:175], v1, s[28:31], s36 offen offset:128 nt
s_waitcnt vmcnt(4)
buffer_load_dwordx4 v[176:179], v1, s[28:31], s36 offen offset:256 nt
buffer_load_dwordx4 v[180:183], v1, s[28:31], s36 offen offset:384 nt
s_add_u32 s36, s36, 49152
s_waitcnt vmcnt(4)
buffer_load_dwordx4 v[184:187], v1, s[28:31], s36 offen offset:0 nt
buffer_load_dwordx4 v[188:191], v1, s[28:31], s36 offen offset:128 nt
s_waitcnt vmcnt(4)
buffer_load_dwordx4 v[192:195], v1, s[28:31], s36 offen offset:256 nt
buffer_load_dwordx4 v[196:199], v1, s[28:31], s36 offen offset:384 nt
s_add_u32 s36, s36, 16384
s_waitcnt vmcnt(4)
buffer_load_dwordx4 v[200:203], v1, s[28:31], s36 offen offset:0 nt
buffer_load_dwordx4 v[204:207], v1, s[28:31], s36 offen offset:128 nt
s_waitcnt vmcnt(4)
buffer_load_dwordx4 v[208:211], v1, s[28:31], s36 offen offset:256 nt
buffer_load_dwordx4 v[212:215], v1, s[28:31], s36 offen offset:384 nt
s_add_u32 s36, s36, 49152
s_waitcnt vmcnt(4)
buffer_load_dwordx4 v[216:219], v1, s[28:31], s36 offen offset:0 nt
buffer_load_dwordx4 v[220:223], v1, s[28:31], s36 offen offset:128 nt
s_waitcnt vmcnt(4)
buffer_load_dwordx4 v[224:227], v1, s[28:31], s36 offen offset:256 nt
buffer_load_dwordx4 v[228:231], v1, s[28:31], s36 offen offset:384 nt
s_add_u32 s36, s36, 16384
s_waitcnt vmcnt(4)
buffer_load_dwordx4 v[232:235], v1, s[28:31], s36 offen offset:0 nt
buffer_load_dwordx4 v[236:239], v1, s[28:31], s36 offen offset:128 nt
s_waitcnt vmcnt(4)
buffer_load_dwordx4 v[240:243], v1, s[28:31], s36 offen offset:256 nt
buffer_load_dwordx4 v[244:247], v1, s[28:31], s36 offen offset:384 nt
s_add_u32 s36, s36, 49152
s_add_u32 s36, s39, 16384
s_barrier
ds_read_b128 v[32:35], v3 offset:0
ds_read_b128 v[36:39], v3 offset:128
ds_read_b128 v[40:43], v3 offset:256
ds_read_b128 v[44:47], v3 offset:384
v_mov_b32 v3, 0
s_waitcnt lgkmcnt(0)
s_waitcnt vmcnt(4)
buffer_load_dwordx4 v[80:83], v1, s[28:31], s36 offen offset:256 nt
buffer_load_dwordx4 v[84:87], v1, s[28:31], s36 offen offset:384 nt
s_add_u32 s36, s36, 376832
v_mfma_f32_16x16x32_bf16 v[12:15], v[56:59], v[32:35], 0
v_mfma_f32_16x16x32_bf16 v[12:15], v[60:63], v[36:39], v[12:15]
s_waitcnt vmcnt(4)
buffer_load_dwordx4 v[56:59], v1, s[28:31], s36 offen offset:0 nt
buffer_load_dwordx4 v[60:63], v1, s[28:31], s36 offen offset:128 nt
v_mfma_f32_16x16x32_bf16 v[12:15], v[64:67], v[40:43], v[12:15]
v_mfma_f32_16x16x32_bf16 v[12:15], v[68:71], v[44:47], v[12:15]
s_nop 7
v_permlane32_swap_b32 v12, v13
v_permlane32_swap_b32 v14, v15
s_nop 0
v_mov_b32_dpp v50, v13 quad_perm:[1,1,3,3] row_mask:0xf bank_mask:0xf
v_mov_b32_dpp v51, v15 quad_perm:[1,1,3,3] row_mask:0xf bank_mask:0xf
s_nop 0
v_add_f32_dpp v48, v12, v50 quad_perm:[0,0,2,2] row_mask:0xf bank_mask:0xf
v_add_f32_dpp v49, v14, v51 quad_perm:[0,0,2,2] row_mask:0xf bank_mask:0xf
v_cvt_pk_bf16_f32 v50, v48, v49
s_mov_b64 exec, s[44:45]
ds_write_b32 v11, v50 offset:0
s_mov_b64 exec, -1
v_lshlrev_b32 v48, 16, v50
v_and_b32 v49, 0xffff0000, v50
v_max3_f32 v9, v48, v49, v9
s_waitcnt vmcnt(4)
buffer_load_dwordx4 v[64:67], v1, s[28:31], s36 offen offset:256 nt
buffer_load_dwordx4 v[68:71], v1, s[28:31], s36 offen offset:384 nt
s_add_u32 s36, s36, 16384
v_mfma_f32_16x16x32_bf16 v[12:15], v[72:75], v[32:35], 0
v_mfma_f32_16x16x32_bf16 v[12:15], v[76:79], v[36:39], v[12:15]
s_waitcnt vmcnt(4)
buffer_load_dwordx4 v[72:75], v1, s[28:31], s36 offen offset:0 nt
buffer_load_dwordx4 v[76:79], v1, s[28:31], s36 offen offset:128 nt
v_mfma_f32_16x16x32_bf16 v[12:15], v[80:83], v[40:43], v[12:15]
v_mfma_f32_16x16x32_bf16 v[12:15], v[84:87], v[44:47], v[12:15]
s_nop 7
v_permlane32_swap_b32 v12, v13
v_permlane32_swap_b32 v14, v15
s_nop 0
v_mov_b32_dpp v50, v13 quad_perm:[1,1,3,3] row_mask:0xf bank_mask:0xf
v_mov_b32_dpp v51, v15 quad_perm:[1,1,3,3] row_mask:0xf bank_mask:0xf
s_nop 0
v_add_f32_dpp v48, v12, v50 quad_perm:[0,0,2,2] row_mask:0xf bank_mask:0xf
v_add_f32_dpp v49, v14, v51 quad_perm:[0,0,2,2] row_mask:0xf bank_mask:0xf
v_cvt_pk_bf16_f32 v50, v48, v49
s_mov_b64 exec, s[44:45]
ds_write_b32 v11, v50 offset:16
s_mov_b64 exec, -1
v_lshlrev_b32 v48, 16, v50
v_and_b32 v49, 0xffff0000, v50
v_max3_f32 v9, v48, v49, v9
v_mfma_f32_16x16x32_bf16 v[12:15], v[88:91], v[32:35], 0
v_mfma_f32_16x16x32_bf16 v[12:15], v[92:95], v[36:39], v[12:15]
v_mfma_f32_16x16x32_bf16 v[12:15], v[96:99], v[40:43], v[12:15]
v_mfma_f32_16x16x32_bf16 v[12:15], v[100:103], v[44:47], v[12:15]
s_nop 7
v_permlane32_swap_b32 v12, v13
v_permlane32_swap_b32 v14, v15
s_nop 0
v_mov_b32_dpp v50, v13 quad_perm:[1,1,3,3] row_mask:0xf bank_mask:0xf
v_mov_b32_dpp v51, v15 quad_perm:[1,1,3,3] row_mask:0xf bank_mask:0xf
s_nop 0
v_add_f32_dpp v48, v12, v50 quad_perm:[0,0,2,2] row_mask:0xf bank_mask:0xf
v_add_f32_dpp v49, v14, v51 quad_perm:[0,0,2,2] row_mask:0xf bank_mask:0xf
v_cvt_pk_bf16_f32 v50, v48, v49
s_mov_b64 exec, s[44:45]
ds_write_b32 v11, v50 offset:32
s_mov_b64 exec, -1
v_lshlrev_b32 v48, 16, v50
v_and_b32 v49, 0xffff0000, v50
v_max3_f32 v9, v48, v49, v9
s_waitcnt vmcnt(4)
buffer_load_dwordx4 v[80:83], v1, s[28:31], s36 offen offset:256 nt
buffer_load_dwordx4 v[84:87], v1, s[28:31], s36 offen offset:384 nt
s_add_u32 s36, s36, 49152
v_mfma_f32_16x16x32_bf16 v[12:15], v[56:59], v[32:35], 0
v_mfma_f32_16x16x32_bf16 v[12:15], v[60:63], v[36:39], v[12:15]
s_waitcnt vmcnt(4)
buffer_load_dwordx4 v[56:59], v1, s[28:31], s36 offen offset:0 nt
buffer_load_dwordx4 v[60:63], v1, s[28:31], s36 offen offset:128 nt
v_mfma_f32_16x16x32_bf16 v[12:15], v[64:67], v[40:43], v[12:15]
v_mfma_f32_16x16x32_bf16 v[12:15], v[68:71], v[44:47], v[12:15]
s_nop 7
v_permlane32_swap_b32 v12, v13
v_permlane32_swap_b32 v14, v15
s_nop 0
v_mov_b32_dpp v50, v13 quad_perm:[1,1,3,3] row_mask:0xf bank_mask:0xf
v_mov_b32_dpp v51, v15 quad_perm:[1,1,3,3] row_mask:0xf bank_mask:0xf
s_nop 0
v_add_f32_dpp v48, v12, v50 quad_perm:[0,0,2,2] row_mask:0xf bank_mask:0xf
v_add_f32_dpp v49, v14, v51 quad_perm:[0,0,2,2] row_mask:0xf bank_mask:0xf
v_cvt_pk_bf16_f32 v50, v48, v49
s_mov_b64 exec, s[44:45]
ds_write_b32 v11, v50 offset:192
s_mov_b64 exec, -1
v_lshlrev_b32 v48, 16, v50
v_and_b32 v49, 0xffff0000, v50
v_max3_f32 v9, v48, v49, v9
v_mfma_f32_16x16x32_bf16 v[12:15], v[104:107], v[32:35], 0
v_mfma_f32_16x16x32_bf16 v[12:15], v[108:111], v[36:39], v[12:15]
v_mfma_f32_16x16x32_bf16 v[12:15], v[112:115], v[40:43], v[12:15]
v_mfma_f32_16x16x32_bf16 v[12:15], v[116:119], v[44:47], v[12:15]
s_nop 7
v_permlane32_swap_b32 v12, v13
v_permlane32_swap_b32 v14, v15
s_nop 0
v_mov_b32_dpp v50, v13 quad_perm:[1,1,3,3] row_mask:0xf bank_mask:0xf
v_mov_b32_dpp v51, v15 quad_perm:[1,1,3,3] row_mask:0xf bank_mask:0xf
s_nop 0
v_add_f32_dpp v48, v12, v50 quad_perm:[0,0,2,2] row_mask:0xf bank_mask:0xf
v_add_f32_dpp v49, v14, v51 quad_perm:[0,0,2,2] row_mask:0xf bank_mask:0xf
v_cvt_pk_bf16_f32 v50, v48, v49
s_mov_b64 exec, s[44:45]
ds_write_b32 v11, v50 offset:48
s_mov_b64 exec, -1
v_lshlrev_b32 v48, 16, v50
v_and_b32 v49, 0xffff0000, v50
v_max3_f32 v9, v48, v49, v9
s_waitcnt vmcnt(4)
buffer_load_dwordx4 v[64:67], v1, s[28:31], s36 offen offset:256 nt
buffer_load_dwordx4 v[68:71], v1, s[28:31], s36 offen offset:384 nt
s_add_u32 s36, s36, 16384
v_mfma_f32_16x16x32_bf16 v[12:15], v[72:75], v[32:35], 0
v_mfma_f32_16x16x32_bf16 v[12:15], v[76:79], v[36:39], v[12:15]
s_waitcnt vmcnt(4)
buffer_load_dwordx4 v[72:75], v1, s[28:31], s36 offen offset:0 nt
buffer_load_dwordx4 v[76:79], v1, s[28:31], s36 offen offset:128 nt
v_mfma_f32_16x16x32_bf16 v[12:15], v[80:83], v[40:43], v[12:15]
v_mfma_f32_16x16x32_bf16 v[12:15], v[84:87], v[44:47], v[12:15]
s_nop 7
v_permlane32_swap_b32 v12, v13
v_permlane32_swap_b32 v14, v15
s_nop 0
v_mov_b32_dpp v50, v13 quad_perm:[1,1,3,3] row_mask:0xf bank_mask:0xf
v_mov_b32_dpp v51, v15 quad_perm:[1,1,3,3] row_mask:0xf bank_mask:0xf
s_nop 0
v_add_f32_dpp v48, v12, v50 quad_perm:[0,0,2,2] row_mask:0xf bank_mask:0xf
v_add_f32_dpp v49, v14, v51 quad_perm:[0,0,2,2] row_mask:0xf bank_mask:0xf
v_cvt_pk_bf16_f32 v50, v48, v49
s_mov_b64 exec, s[44:45]
ds_write_b32 v11, v50 offset:208
s_mov_b64 exec, -1
v_lshlrev_b32 v48, 16, v50
v_and_b32 v49, 0xffff0000, v50
v_max3_f32 v9, v48, v49, v9
v_mfma_f32_16x16x32_bf16 v[12:15], v[120:123], v[32:35], 0
v_mfma_f32_16x16x32_bf16 v[12:15], v[124:127], v[36:39], v[12:15]
v_mfma_f32_16x16x32_bf16 v[12:15], v[128:131], v[40:43], v[12:15]
v_mfma_f32_16x16x32_bf16 v[12:15], v[132:135], v[44:47], v[12:15]
s_nop 7
v_permlane32_swap_b32 v12, v13
v_permlane32_swap_b32 v14, v15
s_nop 0
v_mov_b32_dpp v50, v13 quad_perm:[1,1,3,3] row_mask:0xf bank_mask:0xf
v_mov_b32_dpp v51, v15 quad_perm:[1,1,3,3] row_mask:0xf bank_mask:0xf
s_nop 0
v_add_f32_dpp v48, v12, v50 quad_perm:[0,0,2,2] row_mask:0xf bank_mask:0xf
v_add_f32_dpp v49, v14, v51 quad_perm:[0,0,2,2] row_mask:0xf bank_mask:0xf
v_cvt_pk_bf16_f32 v50, v48, v49
s_mov_b64 exec, s[44:45]
ds_write_b32 v11, v50 offset:64
s_mov_b64 exec, -1
v_lshlrev_b32 v48, 16, v50
v_and_b32 v49, 0xffff0000, v50
v_max3_f32 v9, v48, v49, v9
s_waitcnt vmcnt(4)
buffer_load_dwordx4 v[80:83], v1, s[28:31], s36 offen offset:256 nt
buffer_load_dwordx4 v[84:87], v1, s[28:31], s36 offen offset:384 nt
s_add_u32 s36, s36, 49152
v_mfma_f32_16x16x32_bf16 v[12:15], v[56:59], v[32:35], 0
v_mfma_f32_16x16x32_bf16 v[12:15], v[60:63], v[36:39], v[12:15]
s_waitcnt vmcnt(4)
buffer_load_dwordx4 v[56:59], v1, s[28:31], s36 offen offset:0 nt
buffer_load_dwordx4 v[60:63], v1, s[28:31], s36 offen offset:128 nt
v_mfma_f32_16x16x32_bf16 v[12:15], v[64:67], v[40:43], v[12:15]
v_mfma_f32_16x16x32_bf16 v[12:15], v[68:71], v[44:47], v[12:15]
s_nop 7
v_permlane32_swap_b32 v12, v13
v_permlane32_swap_b32 v14, v15
s_nop 0
v_mov_b32_dpp v50, v13 quad_perm:[1,1,3,3] row_mask:0xf bank_mask:0xf
v_mov_b32_dpp v51, v15 quad_perm:[1,1,3,3] row_mask:0xf bank_mask:0xf
s_nop 0
v_add_f32_dpp v48, v12, v50 quad_perm:[0,0,2,2] row_mask:0xf bank_mask:0xf
v_add_f32_dpp v49, v14, v51 quad_perm:[0,0,2,2] row_mask:0xf bank_mask:0xf
v_cvt_pk_bf16_f32 v50, v48, v49
s_mov_b64 exec, s[44:45]
ds_write_b32 v11, v50 offset:224
s_mov_b64 exec, -1
v_lshlrev_b32 v48, 16, v50
v_and_b32 v49, 0xffff0000, v50
v_max3_f32 v9, v48, v49, v9
v_mfma_f32_16x16x32_bf16 v[12:15], v[136:139], v[32:35], 0
v_mfma_f32_16x16x32_bf16 v[12:15], v[140:143], v[36:39], v[12:15]
v_mfma_f32_16x16x32_bf16 v[12:15], v[144:147], v[40:43], v[12:15]
v_mfma_f32_16x16x32_bf16 v[12:15], v[148:151], v[44:47], v[12:15]
s_nop 7
v_permlane32_swap_b32 v12, v13
v_permlane32_swap_b32 v14, v15
s_nop 0
v_mov_b32_dpp v50, v13 quad_perm:[1,1,3,3] row_mask:0xf bank_mask:0xf
v_mov_b32_dpp v51, v15 quad_perm:[1,1,3,3] row_mask:0xf bank_mask:0xf
s_nop 0
v_add_f32_dpp v48, v12, v50 quad_perm:[0,0,2,2] row_mask:0xf bank_mask:0xf
v_add_f32_dpp v49, v14, v51 quad_perm:[0,0,2,2] row_mask:0xf bank_mask:0xf
v_cvt_pk_bf16_f32 v50, v48, v49
s_mov_b64 exec, s[44:45]
ds_write_b32 v11, v50 offset:80
s_mov_b64 exec, -1
v_lshlrev_b32 v48, 16, v50
v_and_b32 v49, 0xffff0000, v50
v_max3_f32 v9, v48, v49, v9
s_waitcnt vmcnt(4)
buffer_load_dwordx4 v[64:67], v1, s[28:31], s36 offen offset:256 nt
buffer_load_dwordx4 v[68:71], v1, s[28:31], s36 offen offset:384 nt
s_add_u32 s36, s36, 16384
v_mfma_f32_16x16x32_bf16 v[12:15], v[72:75], v[32:35], 0
v_mfma_f32_16x16x32_bf16 v[12:15], v[76:79], v[36:39], v[12:15]
s_waitcnt vmcnt(4)
buffer_load_dwordx4 v[72:75], v1, s[28:31], s36 offen offset:0 nt
buffer_load_dwordx4 v[76:79], v1, s[28:31], s36 offen offset:128 nt
v_mfma_f32_16x16x32_bf16 v[12:15], v[80:83], v[40:43], v[12:15]
v_mfma_f32_16x16x32_bf16 v[12:15], v[84:87], v[44:47], v[12:15]
s_nop 7
v_permlane32_swap_b32 v12, v13
v_permlane32_swap_b32 v14, v15
s_nop 0
v_mov_b32_dpp v50, v13 quad_perm:[1,1,3,3] row_mask:0xf bank_mask:0xf
v_mov_b32_dpp v51, v15 quad_perm:[1,1,3,3] row_mask:0xf bank_mask:0xf
s_nop 0
v_add_f32_dpp v48, v12, v50 quad_perm:[0,0,2,2] row_mask:0xf bank_mask:0xf
v_add_f32_dpp v49, v14, v51 quad_perm:[0,0,2,2] row_mask:0xf bank_mask:0xf
v_cvt_pk_bf16_f32 v50, v48, v49
s_mov_b64 exec, s[44:45]
ds_write_b32 v11, v50 offset:240
s_mov_b64 exec, -1
v_lshlrev_b32 v48, 16, v50
v_and_b32 v49, 0xffff0000, v50
v_max3_f32 v9, v48, v49, v9
v_mfma_f32_16x16x32_bf16 v[12:15], v[152:155], v[32:35], 0
v_mfma_f32_16x16x32_bf16 v[12:15], v[156:159], v[36:39], v[12:15]
v_mfma_f32_16x16x32_bf16 v[12:15], v[160:163], v[40:43], v[12:15]
v_mfma_f32_16x16x32_bf16 v[12:15], v[164:167], v[44:47], v[12:15]
s_nop 7
v_permlane32_swap_b32 v12, v13
v_permlane32_swap_b32 v14, v15
s_nop 0
v_mov_b32_dpp v50, v13 quad_perm:[1,1,3,3] row_mask:0xf bank_mask:0xf
v_mov_b32_dpp v51, v15 quad_perm:[1,1,3,3] row_mask:0xf bank_mask:0xf
s_nop 0
v_add_f32_dpp v48, v12, v50 quad_perm:[0,0,2,2] row_mask:0xf bank_mask:0xf
v_add_f32_dpp v49, v14, v51 quad_perm:[0,0,2,2] row_mask:0xf bank_mask:0xf
v_cvt_pk_bf16_f32 v50, v48, v49
s_mov_b64 exec, s[44:45]
ds_write_b32 v11, v50 offset:96
s_mov_b64 exec, -1
v_lshlrev_b32 v48, 16, v50
v_and_b32 v49, 0xffff0000, v50
v_max3_f32 v9, v48, v49, v9
s_waitcnt vmcnt(4)
buffer_load_dwordx4 v[80:83], v1, s[28:31], s36 offen offset:256 nt
buffer_load_dwordx4 v[84:87], v1, s[28:31], s36 offen offset:384 nt
s_add_u32 s36, s36, 49152
v_mfma_f32_16x16x32_bf16 v[12:15], v[56:59], v[32:35], 0
v_mfma_f32_16x16x32_bf16 v[12:15], v[60:63], v[36:39], v[12:15]
s_waitcnt vmcnt(4)
buffer_load_dwordx4 v[56:59], v1, s[28:31], s36 offen offset:0 nt
buffer_load_dwordx4 v[60:63], v1, s[28:31], s36 offen offset:128 nt
v_mfma_f32_16x16x32_bf16 v[12:15], v[64:67], v[40:43], v[12:15]
v_mfma_f32_16x16x32_bf16 v[12:15], v[68:71], v[44:47], v[12:15]
s_nop 7
v_permlane32_swap_b32 v12, v13
v_permlane32_swap_b32 v14, v15
s_nop 0
v_mov_b32_dpp v50, v13 quad_perm:[1,1,3,3] row_mask:0xf bank_mask:0xf
v_mov_b32_dpp v51, v15 quad_perm:[1,1,3,3] row_mask:0xf bank_mask:0xf
s_nop 0
v_add_f32_dpp v48, v12, v50 quad_perm:[0,0,2,2] row_mask:0xf bank_mask:0xf
v_add_f32_dpp v49, v14, v51 quad_perm:[0,0,2,2] row_mask:0xf bank_mask:0xf
v_cvt_pk_bf16_f32 v50, v48, v49
s_mov_b64 exec, s[44:45]
ds_write_b32 v11, v50 offset:256
s_mov_b64 exec, -1
v_lshlrev_b32 v48, 16, v50
v_and_b32 v49, 0xffff0000, v50
v_max3_f32 v9, v48, v49, v9
v_mfma_f32_16x16x32_bf16 v[12:15], v[168:171], v[32:35], 0
v_mfma_f32_16x16x32_bf16 v[12:15], v[172:175], v[36:39], v[12:15]
v_mfma_f32_16x16x32_bf16 v[12:15], v[176:179], v[40:43], v[12:15]
v_mfma_f32_16x16x32_bf16 v[12:15], v[180:183], v[44:47], v[12:15]
s_nop 7
v_permlane32_swap_b32 v12, v13
v_permlane32_swap_b32 v14, v15
s_nop 0
v_mov_b32_dpp v50, v13 quad_perm:[1,1,3,3] row_mask:0xf bank_mask:0xf
v_mov_b32_dpp v51, v15 quad_perm:[1,1,3,3] row_mask:0xf bank_mask:0xf
s_nop 0
v_add_f32_dpp v48, v12, v50 quad_perm:[0,0,2,2] row_mask:0xf bank_mask:0xf
v_add_f32_dpp v49, v14, v51 quad_perm:[0,0,2,2] row_mask:0xf bank_mask:0xf
v_cvt_pk_bf16_f32 v50, v48, v49
s_mov_b64 exec, s[44:45]
ds_write_b32 v11, v50 offset:112
s_mov_b64 exec, -1
v_lshlrev_b32 v48, 16, v50
v_and_b32 v49, 0xffff0000, v50
v_max3_f32 v9, v48, v49, v9
s_waitcnt vmcnt(4)
buffer_load_dwordx4 v[64:67], v1, s[28:31], s36 offen offset:256 nt
buffer_load_dwordx4 v[68:71], v1, s[28:31], s36 offen offset:384 nt
s_add_u32 s36, s36, 16384
v_mfma_f32_16x16x32_bf16 v[12:15], v[72:75], v[32:35], 0
v_mfma_f32_16x16x32_bf16 v[12:15], v[76:79], v[36:39], v[12:15]
s_waitcnt vmcnt(4)
buffer_load_dwordx4 v[72:75], v1, s[28:31], s36 offen offset:0 nt
buffer_load_dwordx4 v[76:79], v1, s[28:31], s36 offen offset:128 nt
v_mfma_f32_16x16x32_bf16 v[12:15], v[80:83], v[40:43], v[12:15]
v_mfma_f32_16x16x32_bf16 v[12:15], v[84:87], v[44:47], v[12:15]
s_nop 7
v_permlane32_swap_b32 v12, v13
v_permlane32_swap_b32 v14, v15
s_nop 0
v_mov_b32_dpp v50, v13 quad_perm:[1,1,3,3] row_mask:0xf bank_mask:0xf
v_mov_b32_dpp v51, v15 quad_perm:[1,1,3,3] row_mask:0xf bank_mask:0xf
s_nop 0
v_add_f32_dpp v48, v12, v50 quad_perm:[0,0,2,2] row_mask:0xf bank_mask:0xf
v_add_f32_dpp v49, v14, v51 quad_perm:[0,0,2,2] row_mask:0xf bank_mask:0xf
v_cvt_pk_bf16_f32 v50, v48, v49
s_mov_b64 exec, s[44:45]
ds_write_b32 v11, v50 offset:272
s_mov_b64 exec, -1
v_lshlrev_b32 v48, 16, v50
v_and_b32 v49, 0xffff0000, v50
v_max3_f32 v9, v48, v49, v9
v_mfma_f32_16x16x32_bf16 v[12:15], v[184:187], v[32:35], 0
v_mfma_f32_16x16x32_bf16 v[12:15], v[188:191], v[36:39], v[12:15]
v_mfma_f32_16x16x32_bf16 v[12:15], v[192:195], v[40:43], v[12:15]
v_mfma_f32_16x16x32_bf16 v[12:15], v[196:199], v[44:47], v[12:15]
s_nop 7
v_permlane32_swap_b32 v12, v13
v_permlane32_swap_b32 v14, v15
s_nop 0
v_mov_b32_dpp v50, v13 quad_perm:[1,1,3,3] row_mask:0xf bank_mask:0xf
v_mov_b32_dpp v51, v15 quad_perm:[1,1,3,3] row_mask:0xf bank_mask:0xf
s_nop 0
v_add_f32_dpp v48, v12, v50 quad_perm:[0,0,2,2] row_mask:0xf bank_mask:0xf
v_add_f32_dpp v49, v14, v51 quad_perm:[0,0,2,2] row_mask:0xf bank_mask:0xf
v_cvt_pk_bf16_f32 v50, v48, v49
s_mov_b64 exec, s[44:45]
ds_write_b32 v11, v50 offset:128
s_mov_b64 exec, -1
v_lshlrev_b32 v48, 16, v50
v_and_b32 v49, 0xffff0000, v50
v_max3_f32 v9, v48, v49, v9
s_waitcnt vmcnt(4)
buffer_load_dwordx4 v[80:83], v1, s[28:31], s36 offen offset:256 nt
buffer_load_dwordx4 v[84:87], v1, s[28:31], s36 offen offset:384 nt
s_add_u32 s36, s36, 49152
v_mfma_f32_16x16x32_bf16 v[12:15], v[56:59], v[32:35], 0
v_mfma_f32_16x16x32_bf16 v[12:15], v[60:63], v[36:39], v[12:15]
s_waitcnt vmcnt(4)
buffer_load_dwordx4 v[56:59], v1, s[28:31], s36 offen offset:0 nt
buffer_load_dwordx4 v[60:63], v1, s[28:31], s36 offen offset:128 nt
v_mfma_f32_16x16x32_bf16 v[12:15], v[64:67], v[40:43], v[12:15]
v_mfma_f32_16x16x32_bf16 v[12:15], v[68:71], v[44:47], v[12:15]
s_nop 7
v_permlane32_swap_b32 v12, v13
v_permlane32_swap_b32 v14, v15
s_nop 0
v_mov_b32_dpp v50, v13 quad_perm:[1,1,3,3] row_mask:0xf bank_mask:0xf
v_mov_b32_dpp v51, v15 quad_perm:[1,1,3,3] row_mask:0xf bank_mask:0xf
s_nop 0
v_add_f32_dpp v48, v12, v50 quad_perm:[0,0,2,2] row_mask:0xf bank_mask:0xf
v_add_f32_dpp v49, v14, v51 quad_perm:[0,0,2,2] row_mask:0xf bank_mask:0xf
v_cvt_pk_bf16_f32 v50, v48, v49
s_mov_b64 exec, s[44:45]
ds_write_b32 v11, v50 offset:288
s_mov_b64 exec, -1
v_lshlrev_b32 v48, 16, v50
v_and_b32 v49, 0xffff0000, v50
v_max3_f32 v9, v48, v49, v9
v_mfma_f32_16x16x32_bf16 v[12:15], v[200:203], v[32:35], 0
v_mfma_f32_16x16x32_bf16 v[12:15], v[204:207], v[36:39], v[12:15]
v_mfma_f32_16x16x32_bf16 v[12:15], v[208:211], v[40:43], v[12:15]
v_mfma_f32_16x16x32_bf16 v[12:15], v[212:215], v[44:47], v[12:15]
s_nop 7
v_permlane32_swap_b32 v12, v13
v_permlane32_swap_b32 v14, v15
s_nop 0
v_mov_b32_dpp v50, v13 quad_perm:[1,1,3,3] row_mask:0xf bank_mask:0xf
v_mov_b32_dpp v51, v15 quad_perm:[1,1,3,3] row_mask:0xf bank_mask:0xf
s_nop 0
v_add_f32_dpp v48, v12, v50 quad_perm:[0,0,2,2] row_mask:0xf bank_mask:0xf
v_add_f32_dpp v49, v14, v51 quad_perm:[0,0,2,2] row_mask:0xf bank_mask:0xf
v_cvt_pk_bf16_f32 v50, v48, v49
s_mov_b64 exec, s[44:45]
ds_write_b32 v11, v50 offset:144
s_mov_b64 exec, -1
v_lshlrev_b32 v48, 16, v50
v_and_b32 v49, 0xffff0000, v50
v_max3_f32 v9, v48, v49, v9
s_waitcnt vmcnt(4)
buffer_load_dwordx4 v[64:67], v1, s[28:31], s36 offen offset:256 nt
buffer_load_dwordx4 v[68:71], v1, s[28:31], s36 offen offset:384 nt
s_add_u32 s36, s36, 16384
v_mfma_f32_16x16x32_bf16 v[12:15], v[72:75], v[32:35], 0
v_mfma_f32_16x16x32_bf16 v[12:15], v[76:79], v[36:39], v[12:15]
s_waitcnt vmcnt(4)
buffer_load_dwordx4 v[72:75], v1, s[28:31], s36 offen offset:0 nt
buffer_load_dwordx4 v[76:79], v1, s[28:31], s36 offen offset:128 nt
v_mfma_f32_16x16x32_bf16 v[12:15], v[80:83], v[40:43], v[12:15]
v_mfma_f32_16x16x32_bf16 v[12:15], v[84:87], v[44:47], v[12:15]
s_nop 7
v_permlane32_swap_b32 v12, v13
v_permlane32_swap_b32 v14, v15
s_nop 0
v_mov_b32_dpp v50, v13 quad_perm:[1,1,3,3] row_mask:0xf bank_mask:0xf
v_mov_b32_dpp v51, v15 quad_perm:[1,1,3,3] row_mask:0xf bank_mask:0xf
s_nop 0
v_add_f32_dpp v48, v12, v50 quad_perm:[0,0,2,2] row_mask:0xf bank_mask:0xf
v_add_f32_dpp v49, v14, v51 quad_perm:[0,0,2,2] row_mask:0xf bank_mask:0xf
v_cvt_pk_bf16_f32 v50, v48, v49
s_mov_b64 exec, s[44:45]
ds_write_b32 v11, v50 offset:304
s_mov_b64 exec, -1
v_lshlrev_b32 v48, 16, v50
v_and_b32 v49, 0xffff0000, v50
v_max3_f32 v9, v48, v49, v9
v_mfma_f32_16x16x32_bf16 v[12:15], v[216:219], v[32:35], 0
v_mfma_f32_16x16x32_bf16 v[12:15], v[220:223], v[36:39], v[12:15]
v_mfma_f32_16x16x32_bf16 v[12:15], v[224:227], v[40:43], v[12:15]
v_mfma_f32_16x16x32_bf16 v[12:15], v[228:231], v[44:47], v[12:15]
s_nop 7
v_permlane32_swap_b32 v12, v13
v_permlane32_swap_b32 v14, v15
s_nop 0
v_mov_b32_dpp v50, v13 quad_perm:[1,1,3,3] row_mask:0xf bank_mask:0xf
v_mov_b32_dpp v51, v15 quad_perm:[1,1,3,3] row_mask:0xf bank_mask:0xf
s_nop 0
v_add_f32_dpp v48, v12, v50 quad_perm:[0,0,2,2] row_mask:0xf bank_mask:0xf
v_add_f32_dpp v49, v14, v51 quad_perm:[0,0,2,2] row_mask:0xf bank_mask:0xf
v_cvt_pk_bf16_f32 v50, v48, v49
s_mov_b64 exec, s[44:45]
ds_write_b32 v11, v50 offset:160
s_mov_b64 exec, -1
v_lshlrev_b32 v48, 16, v50
v_and_b32 v49, 0xffff0000, v50
v_max3_f32 v9, v48, v49, v9
s_waitcnt vmcnt(4)
buffer_load_dwordx4 v[80:83], v1, s[28:31], s36 offen offset:256 nt
buffer_load_dwordx4 v[84:87], v1, s[28:31], s36 offen offset:384 nt
s_add_u32 s36, s36, 49152
v_mfma_f32_16x16x32_bf16 v[12:15], v[56:59], v[32:35], 0
v_mfma_f32_16x16x32_bf16 v[12:15], v[60:63], v[36:39], v[12:15]
s_waitcnt vmcnt(4)
buffer_load_dwordx4 v[56:59], v1, s[28:31], s36 offen offset:0 nt
buffer_load_dwordx4 v[60:63], v1, s[28:31], s36 offen offset:128 nt
v_mfma_f32_16x16x32_bf16 v[12:15], v[64:67], v[40:43], v[12:15]
v_mfma_f32_16x16x32_bf16 v[12:15], v[68:71], v[44:47], v[12:15]
s_nop 7
v_permlane32_swap_b32 v12, v13
v_permlane32_swap_b32 v14, v15
s_nop 0
v_mov_b32_dpp v50, v13 quad_perm:[1,1,3,3] row_mask:0xf bank_mask:0xf
v_mov_b32_dpp v51, v15 quad_perm:[1,1,3,3] row_mask:0xf bank_mask:0xf
s_nop 0
v_add_f32_dpp v48, v12, v50 quad_perm:[0,0,2,2] row_mask:0xf bank_mask:0xf
v_add_f32_dpp v49, v14, v51 quad_perm:[0,0,2,2] row_mask:0xf bank_mask:0xf
v_cvt_pk_bf16_f32 v50, v48, v49
s_mov_b64 exec, s[44:45]
ds_write_b32 v11, v50 offset:320
s_mov_b64 exec, -1
v_lshlrev_b32 v48, 16, v50
v_and_b32 v49, 0xffff0000, v50
v_max3_f32 v9, v48, v49, v9
v_mfma_f32_16x16x32_bf16 v[12:15], v[232:235], v[32:35], 0
v_mfma_f32_16x16x32_bf16 v[12:15], v[236:239], v[36:39], v[12:15]
v_mfma_f32_16x16x32_bf16 v[12:15], v[240:243], v[40:43], v[12:15]
v_mfma_f32_16x16x32_bf16 v[12:15], v[244:247], v[44:47], v[12:15]
s_nop 7
v_permlane32_swap_b32 v12, v13
v_permlane32_swap_b32 v14, v15
s_nop 0
v_mov_b32_dpp v50, v13 quad_perm:[1,1,3,3] row_mask:0xf bank_mask:0xf
v_mov_b32_dpp v51, v15 quad_perm:[1,1,3,3] row_mask:0xf bank_mask:0xf
s_nop 0
v_add_f32_dpp v48, v12, v50 quad_perm:[0,0,2,2] row_mask:0xf bank_mask:0xf
v_add_f32_dpp v49, v14, v51 quad_perm:[0,0,2,2] row_mask:0xf bank_mask:0xf
v_cvt_pk_bf16_f32 v50, v48, v49
s_mov_b64 exec, s[44:45]
ds_write_b32 v11, v50 offset:176
s_mov_b64 exec, -1
v_lshlrev_b32 v48, 16, v50
v_and_b32 v49, 0xffff0000, v50
v_max3_f32 v9, v48, v49, v9
s_waitcnt vmcnt(4)
buffer_load_dwordx4 v[64:67], v1, s[28:31], s36 offen offset:256 nt
buffer_load_dwordx4 v[68:71], v1, s[28:31], s36 offen offset:384 nt
s_add_u32 s36, s36, 16384
v_mfma_f32_16x16x32_bf16 v[12:15], v[72:75], v[32:35], 0
v_mfma_f32_16x16x32_bf16 v[12:15], v[76:79], v[36:39], v[12:15]
s_waitcnt vmcnt(4)
buffer_load_dwordx4 v[72:75], v1, s[28:31], s36 offen offset:0 nt
buffer_load_dwordx4 v[76:79], v1, s[28:31], s36 offen offset:128 nt
v_mfma_f32_16x16x32_bf16 v[12:15], v[80:83], v[40:43], v[12:15]
v_mfma_f32_16x16x32_bf16 v[12:15], v[84:87], v[44:47], v[12:15]
s_nop 7
v_permlane32_swap_b32 v12, v13
v_permlane32_swap_b32 v14, v15
s_nop 0
v_mov_b32_dpp v50, v13 quad_perm:[1,1,3,3] row_mask:0xf bank_mask:0xf
v_mov_b32_dpp v51, v15 quad_perm:[1,1,3,3] row_mask:0xf bank_mask:0xf
s_nop 0
v_add_f32_dpp v48, v12, v50 quad_perm:[0,0,2,2] row_mask:0xf bank_mask:0xf
v_add_f32_dpp v49, v14, v51 quad_perm:[0,0,2,2] row_mask:0xf bank_mask:0xf
v_cvt_pk_bf16_f32 v50, v48, v49
s_mov_b64 exec, s[44:45]
ds_write_b32 v11, v50 offset:336
s_mov_b64 exec, -1
v_lshlrev_b32 v48, 16, v50
v_and_b32 v49, 0xffff0000, v50
v_max3_f32 v9, v48, v49, v9
v_add_u32 v11, 352, v11
s_mov_b32 s37, 24
L_loop1:
s_waitcnt vmcnt(4)
buffer_load_dwordx4 v[80:83], v1, s[28:31], s36 offen offset:256 nt
buffer_load_dwordx4 v[84:87], v1, s[28:31], s36 offen offset:384 nt
s_add_u32 s36, s36, 49152
v_mfma_f32_16x16x32_bf16 v[12:15], v[56:59], v[32:35], 0
v_mfma_f32_16x16x32_bf16 v[12:15], v[60:63], v[36:39], v[12:15]
s_waitcnt vmcnt(4)
buffer_load_dwordx4 v[56:59], v1, s[28:31], s36 offen offset:0 nt
buffer_load_dwordx4 v[60:63], v1, s[28:31], s36 offen offset:128 nt
v_mfma_f32_16x16x32_bf16 v[12:15], v[64:67], v[40:43], v[12:15]
v_mfma_f32_16x16x32_bf16 v[12:15], v[68:71], v[44:47], v[12:15]
s_nop 7
v_permlane32_swap_b32 v12, v13
v_permlane32_swap_b32 v14, v15
s_nop 0
v_mov_b32_dpp v50, v13 quad_perm:[1,1,3,3] row_mask:0xf bank_mask:0xf
v_mov_b32_dpp v51, v15 quad_perm:[1,1,3,3] row_mask:0xf bank_mask:0xf
s_nop 0
v_add_f32_dpp v48, v12, v50 quad_perm:[0,0,2,2] row_mask:0xf bank_mask:0xf
v_add_f32_dpp v49, v14, v51 quad_perm:[0,0,2,2] row_mask:0xf bank_mask:0xf
v_cvt_pk_bf16_f32 v50, v48, v49
s_mov_b64 exec, s[44:45]
ds_write_b32 v11, v50 offset:0
s_mov_b64 exec, -1
v_lshlrev_b32 v48, 16, v50
v_and_b32 v49, 0xffff0000, v50
v_max3_f32 v9, v48, v49, v9
s_waitcnt vmcnt(4)
buffer_load_dwordx4 v[64:67], v1, s[28:31], s36 offen offset:256 nt
buffer_load_dwordx4 v[68:71], v1, s[28:31], s36 offen offset:384 nt
s_add_u32 s36, s36, 16384
v_mfma_f32_16x16x32_bf16 v[12:15], v[72:75], v[32:35], 0
v_mfma_f32_16x16x32_bf16 v[12:15], v[76:79], v[36:39], v[12:15]
s_waitcnt vmcnt(4)
buffer_load_dwordx4 v[72:75], v1, s[28:31], s36 offen offset:0 nt
buffer_load_dwordx4 v[76:79], v1, s[28:31], s36 offen offset:128 nt
v_mfma_f32_16x16x32_bf16 v[12:15], v[80:83], v[40:43], v[12:15]
v_mfma_f32_16x16x32_bf16 v[12:15], v[84:87], v[44:47], v[12:15]
s_nop 7
v_permlane32_swap_b32 v12, v13
v_permlane32_swap_b32 v14, v15
s_nop 0
v_mov_b32_dpp v50, v13 quad_perm:[1,1,3,3] row_mask:0xf bank_mask:0xf
v_mov_b32_dpp v51, v15 quad_perm:[1,1,3,3] row_mask:0xf bank_mask:0xf
s_nop 0
v_add_f32_dpp v48, v12, v50 quad_perm:[0,0,2,2] row_mask:0xf bank_mask:0xf
v_add_f32_dpp v49, v14, v51 quad_perm:[0,0,2,2] row_mask:0xf bank_mask:0xf
v_cvt_pk_bf16_f32 v50, v48, v49
s_mov_b64 exec, s[44:45]
ds_write_b32 v11, v50 offset:16
s_mov_b64 exec, -1
v_lshlrev_b32 v48, 16, v50
v_and_b32 v49, 0xffff0000, v50
v_max3_f32 v9, v48, v49, v9
v_add_u32 v11, 32, v11
s_add_u32 s37, s37, 2
s_cmp_lt_u32 s37, 64
s_cbranch_scc1 L_loop1
s_waitcnt vmcnt(4)
buffer_load_dwordx4 v[80:83], v1, s[28:31], s36 offen offset:256 nt
buffer_load_dwordx4 v[84:87], v1, s[28:31], s36 offen offset:384 nt
s_mov_b32 s36, s39
v_mfma_f32_16x16x32_bf16 v[12:15], v[56:59], v[32:35], 0
v_mfma_f32_16x16x32_bf16 v[12:15], v[60:63], v[36:39], v[12:15]
s_waitcnt vmcnt(4)
buffer_load_dwordx4 v[56:59], v2, s[32:35], s36 offen offset:0 nt
buffer_load_dwordx4 v[60:63], v2, s[32:35], s36 offen offset:256 nt
v_mfma_f32_16x16x32_bf16 v[12:15], v[64:67], v[40:43], v[12:15]
v_mfma_f32_16x16x32_bf16 v[12:15], v[68:71], v[44:47], v[12:15]
s_nop 7
v_permlane32_swap_b32 v12, v13
v_permlane32_swap_b32 v14, v15
s_nop 0
v_mov_b32_dpp v50, v13 quad_perm:[1,1,3,3] row_mask:0xf bank_mask:0xf
v_mov_b32_dpp v51, v15 quad_perm:[1,1,3,3] row_mask:0xf bank_mask:0xf
s_nop 0
v_add_f32_dpp v48, v12, v50 quad_perm:[0,0,2,2] row_mask:0xf bank_mask:0xf
v_add_f32_dpp v49, v14, v51 quad_perm:[0,0,2,2] row_mask:0xf bank_mask:0xf
v_cvt_pk_bf16_f32 v50, v48, v49
s_mov_b64 exec, s[44:45]
ds_write_b32 v11, v50 offset:0
s_mov_b64 exec, -1
v_lshlrev_b32 v48, 16, v50
v_and_b32 v49, 0xffff0000, v50
v_max3_f32 v9, v48, v49, v9
s_waitcnt vmcnt(4)
buffer_load_dwordx4 v[64:67], v2, s[32:35], s36 offen offset:1024 nt
buffer_load_dwordx4 v[68:71], v2, s[32:35], s36 offen offset:1280 nt
s_add_u32 s36, s36, 16384
v_mfma_f32_16x16x32_bf16 v[12:15], v[72:75], v[32:35], 0
v_mfma_f32_16x16x32_bf16 v[12:15], v[76:79], v[36:39], v[12:15]
s_waitcnt vmcnt(4)
buffer_load_dwordx4 v[72:75], v2, s[32:35], s36 offen offset:0 nt
buffer_load_dwordx4 v[76:79], v2, s[32:35], s36 offen offset:256 nt
v_mfma_f32_16x16x32_bf16 v[12:15], v[80:83], v[40:43], v[12:15]
v_mfma_f32_16x16x32_bf16 v[12:15], v[84:87], v[44:47], v[12:15]
s_nop 7
v_permlane32_swap_b32 v12, v13
v_permlane32_swap_b32 v14, v15
s_nop 0
v_mov_b32_dpp v50, v13 quad_perm:[1,1,3,3] row_mask:0xf bank_mask:0xf
v_mov_b32_dpp v51, v15 quad_perm:[1,1,3,3] row_mask:0xf bank_mask:0xf
s_nop 0
v_add_f32_dpp v48, v12, v50 quad_perm:[0,0,2,2] row_mask:0xf bank_mask:0xf
v_add_f32_dpp v49, v14, v51 quad_perm:[0,0,2,2] row_mask:0xf bank_mask:0xf
v_cvt_pk_bf16_f32 v50, v48, v49
s_mov_b64 exec, s[44:45]
ds_write_b32 v11, v50 offset:16
s_mov_b64 exec, -1
v_lshlrev_b32 v48, 16, v50
v_and_b32 v49, 0xffff0000, v50
v_max3_f32 v9, v48, v49, v9
v_mov_b32 v52, v9
s_nop 1
v_permlane16_swap_b32 v9, v52
v_max_f32 v9, v9, v52
v_mov_b32 v52, v9
s_nop 1
v_permlane32_swap_b32 v9, v52
v_max_f32 v9, v9, v52
s_lshl_b32 s43, s3, 2
v_mov_b32 v50, s43
v_add_u32 v11, s53, v53
s_mov_b32 s37, 2
s_waitcnt lgkmcnt(0)
s_mov_b64 exec, 1
ds_write_b32 v50, v9 offset:656
s_mov_b64 exec, -1
ds_read_b32 v54, v11 offset:0
ds_read_b32 v55, v11 offset:16
L_loop2:
s_waitcnt lgkmcnt(0)
v_lshlrev_b32 v48, 16, v54
v_and_b32 v49, 0xffff0000, v54
v_sub_f32 v48, v48, v9
v_sub_f32 v49, v49, v9
v_mul_f32 v48, s40, v48
v_mul_f32 v49, s40, v49
v_exp_f32 v48, v48
v_exp_f32 v49, v49
s_nop 0
v_cvt_pk_bf16_f32 v50, v48, v49
v_lshlrev_b32 v51, 16, v50
v_and_b32 v52, 0xffff0000, v50
v_fma_f32 v48, -v51, v8, v48
v_fma_f32 v49, -v52, v8, v49
v_cvt_pk_bf16_f32 v50, v48, v48
v_cvt_pk_bf16_f32 v51, v49, v49
v_and_b32 v24, v50, v4
v_and_b32 v25, v50, v5
v_and_b32 v26, v50, v6
v_and_b32 v27, v50, v7
v_and_b32 v28, v51, v4
v_and_b32 v29, v51, v5
v_and_b32 v30, v51, v6
v_and_b32 v31, v51, v7
ds_read_b32 v54, v11 offset:32
s_waitcnt vmcnt(4)
buffer_load_dwordx4 v[80:83], v2, s[32:35], s36 offen offset:1024 nt
buffer_load_dwordx4 v[84:87], v2, s[32:35], s36 offen offset:1280 nt
s_add_u32 s36, s36, 49152
v_mfma_f32_16x16x32_bf16 v[16:19], v[56:59], v[24:27], v[16:19]
v_mfma_f32_16x16x32_bf16 v[20:23], v[60:63], v[24:27], v[20:23]
s_waitcnt vmcnt(4)
buffer_load_dwordx4 v[56:59], v2, s[32:35], s36 offen offset:0 nt
buffer_load_dwordx4 v[60:63], v2, s[32:35], s36 offen offset:256 nt
v_mfma_f32_16x16x32_bf16 v[16:19], v[64:67], v[28:31], v[16:19]
v_mfma_f32_16x16x32_bf16 v[20:23], v[68:71], v[28:31], v[20:23]
s_waitcnt lgkmcnt(0)
v_lshlrev_b32 v48, 16, v55
v_and_b32 v49, 0xffff0000, v55
v_sub_f32 v48, v48, v9
v_sub_f32 v49, v49, v9
v_mul_f32 v48, s40, v48
v_mul_f32 v49, s40, v49
v_exp_f32 v48, v48
v_exp_f32 v49, v49
s_nop 0
v_cvt_pk_bf16_f32 v50, v48, v49
v_lshlrev_b32 v51, 16, v50
v_and_b32 v52, 0xffff0000, v50
v_fma_f32 v48, -v51, v8, v48
v_fma_f32 v49, -v52, v8, v49
v_cvt_pk_bf16_f32 v50, v48, v48
v_cvt_pk_bf16_f32 v51, v49, v49
v_and_b32 v24, v50, v4
v_and_b32 v25, v50, v5
v_and_b32 v26, v50, v6
v_and_b32 v27, v50, v7
v_and_b32 v28, v51, v4
v_and_b32 v29, v51, v5
v_and_b32 v30, v51, v6
v_and_b32 v31, v51, v7
ds_read_b32 v55, v11 offset:48
s_waitcnt vmcnt(4)
buffer_load_dwordx4 v[64:67], v2, s[32:35], s36 offen offset:1024 nt
buffer_load_dwordx4 v[68:71], v2, s[32:35], s36 offen offset:1280 nt
s_add_u32 s36, s36, 16384
v_mfma_f32_16x16x32_bf16 v[16:19], v[72:75], v[24:27], v[16:19]
v_mfma_f32_16x16x32_bf16 v[20:23], v[76:79], v[24:27], v[20:23]
s_waitcnt vmcnt(4)
buffer_load_dwordx4 v[72:75], v2, s[32:35], s36 offen offset:0 nt
buffer_load_dwordx4 v[76:79], v2, s[32:35], s36 offen offset:256 nt
v_mfma_f32_16x16x32_bf16 v[16:19], v[80:83], v[28:31], v[16:19]
v_mfma_f32_16x16x32_bf16 v[20:23], v[84:87], v[28:31], v[20:23]
v_add_u32 v11, 32, v11
s_add_u32 s37, s37, 2
s_cmp_lg_u32 s37, 54
s_nop 3
s_cbranch_scc1 L_nokick
ds_write_b32 v3, v3 offset:672
L_nokick:
s_cmp_lt_u32 s37, 56
s_cbranch_scc1 L_loop2
s_mov_b32 s37, 0
s_waitcnt lgkmcnt(0)
v_lshlrev_b32 v48, 16, v54
v_and_b32 v49, 0xffff0000, v54
v_sub_f32 v48, v48, v9
v_sub_f32 v49, v49, v9
v_mul_f32 v48, s40, v48
v_mul_f32 v49, s40, v49
v_exp_f32 v48, v48
v_exp_f32 v49, v49
s_nop 0
v_cvt_pk_bf16_f32 v50, v48, v49
v_lshlrev_b32 v51, 16, v50
v_and_b32 v52, 0xffff0000, v50
v_fma_f32 v48, -v51, v8, v48
v_fma_f32 v49, -v52, v8, v49
v_cvt_pk_bf16_f32 v50, v48, v48
v_cvt_pk_bf16_f32 v51, v49, v49
v_and_b32 v24, v50, v4
v_and_b32 v25, v50, v5
v_and_b32 v26, v50, v6
v_and_b32 v27, v50, v7
v_and_b32 v28, v51, v4
v_and_b32 v29, v51, v5
v_and_b32 v30, v51, v6
v_and_b32 v31, v51, v7
s_waitcnt vmcnt(4)
buffer_load_dwordx4 v[80:83], v2, s[32:35], s36 offen offset:1024 nt
buffer_load_dwordx4 v[84:87], v2, s[32:35], s36 offen offset:1280 nt
s_cmp_eq_u32 s34, 0
s_cbranch_scc1 L_nobar1
s_barrier
L_nobar1:
ds_read_b32 v10, v3 offset:512
s_add_u32 s37, s37, 1
v_mfma_f32_16x16x32_bf16 v[16:19], v[56:59], v[24:27], v[16:19]
v_mfma_f32_16x16x32_bf16 v[20:23], v[60:63], v[24:27], v[20:23]
s_waitcnt lgkmcnt(0)
v_readfirstlane_b32 s43, v10
s_cmp_gt_u32 s37, 1100
s_cselect_b32 s34, 0, s34
s_cmp_lt_u32 s43, 128
s_cselect_b32 s34, s34, 0
s_mov_b32 s38, s34
s_min_u32 s43, s43, 127
s_lshr_b32 s36, s43, 5
s_lshl_b32 s36, s36, 2
s_and_b32 s57, s43, 3
s_add_u32 s36, s36, s57
s_lshl_b32 s36, s36, 14
s_bfe_u32 s57, s43, 0x30002
s_lshl_b32 s57, s57, 21
s_add_u32 s36, s36, s57
s_add_u32 s36, s36, s41
s_lshl_b32 s43, s43, 6
s_add_u32 s43, s43, s52
buffer_load_dword v54, v53, s[48:51], s43 offen sc1
s_waitcnt vmcnt(5)
buffer_load_dwordx4 v[56:59], v2, s[32:35], s36 offen offset:0 nt
buffer_load_dwordx4 v[60:63], v2, s[32:35], s36 offen offset:256 nt
v_mfma_f32_16x16x32_bf16 v[16:19], v[64:67], v[28:31], v[16:19]
v_mfma_f32_16x16x32_bf16 v[20:23], v[68:71], v[28:31], v[20:23]
v_lshlrev_b32 v48, 16, v55
v_and_b32 v49, 0xffff0000, v55
v_sub_f32 v48, v48, v9
v_sub_f32 v49, v49, v9
v_mul_f32 v48, s40, v48
v_mul_f32 v49, s40, v49
v_exp_f32 v48, v48
v_exp_f32 v49, v49
s_nop 0
v_cvt_pk_bf16_f32 v50, v48, v49
v_lshlrev_b32 v51, 16, v50
v_and_b32 v52, 0xffff0000, v50
v_fma_f32 v48, -v51, v8, v48
v_fma_f32 v49, -v52, v8, v49
v_cvt_pk_bf16_f32 v50, v48, v48
v_cvt_pk_bf16_f32 v51, v49, v49
v_and_b32 v24, v50, v4
v_and_b32 v25, v50, v5
v_and_b32 v26, v50, v6
v_and_b32 v27, v50, v7
v_and_b32 v28, v51, v4
v_and_b32 v29, v51, v5
v_and_b32 v30, v51, v6
v_and_b32 v31, v51, v7
s_waitcnt vmcnt(5)
buffer_load_dwordx4 v[64:67], v2, s[32:35], s36 offen offset:1024 nt
buffer_load_dwordx4 v[68:71], v2, s[32:35], s36 offen offset:1280 nt
s_cmp_eq_u32 s34, 0
s_cbranch_scc1 L_nobar2
s_barrier
L_nobar2:
ds_read_b32 v10, v3 offset:516
s_add_u32 s37, s37, 1
v_mfma_f32_16x16x32_bf16 v[16:19], v[72:75], v[24:27], v[16:19]
v_mfma_f32_16x16x32_bf16 v[20:23], v[76:79], v[24:27], v[20:23]
s_waitcnt lgkmcnt(0)
v_readfirstlane_b32 s43, v10
s_cmp_gt_u32 s37, 1100
s_cselect_b32 s34, 0, s34
s_cmp_lt_u32 s43, 128
s_cselect_b32 s34, s34, 0
s_mov_b32 s39, s34
s_min_u32 s43, s43, 127
s_lshr_b32 s36, s43, 5
s_lshl_b32 s36, s36, 2
s_and_b32 s57, s43, 3
s_add_u32 s36, s36, s57
s_lshl_b32 s36, s36, 14
s_bfe_u32 s57, s43, 0x30002
s_lshl_b32 s57, s57, 21
s_add_u32 s36, s36, s57
s_add_u32 s36, s36, s41
s_lshl_b32 s43, s43, 6
s_add_u32 s43, s43, s52
buffer_load_dword v55, v53, s[48:51], s43 offen sc1
s_waitcnt vmcnt(6)
buffer_load_dwordx4 v[72:75], v2, s[32:35], s36 offen offset:0 nt
buffer_load_dwordx4 v[76:79], v2, s[32:35], s36 offen offset:256 nt
v_mfma_f32_16x16x32_bf16 v[16:19], v[80:83], v[28:31], v[16:19]
v_mfma_f32_16x16x32_bf16 v[20:23], v[84:87], v[28:31], v[20:23]
ds_read_b32 v51, v3 offset:520
s_waitcnt lgkmcnt(0)
v_sub_f32 v52, v9, v51
v_mul_f32 v52, s40, v52
v_exp_f32 v52, v52
v_mov_b32 v9, v51
s_nop 0
v_mul_f32 v16, v16, v52
v_mul_f32 v17, v17, v52
v_mul_f32 v18, v18, v52
v_mul_f32 v19, v19, v52
v_mul_f32 v20, v20, v52
v_mul_f32 v21, v21, v52
v_mul_f32 v22, v22, v52
v_mul_f32 v23, v23, v52
s_mov_b32 s46, 0xff00ff00
s_mov_b32 s47, 0xff00ff00
s_lshl_b32 s43, s3, 10
v_lshl_add_u32 v11, v0, 4, s43
L_loop3:
s_cmp_eq_u32 s38, 0
s_cbranch_scc1 L_sdone
s_waitcnt vmcnt(7)
v_lshlrev_b32 v48, 16, v54
v_and_b32 v49, 0xffff0000, v54
v_sub_f32 v48, v48, v9
v_sub_f32 v49, v49, v9
v_mul_f32 v48, s40, v48
v_mul_f32 v49, s40, v49
v_exp_f32 v48, v48
v_exp_f32 v49, v49
s_nop 0
v_cvt_pk_bf16_f32 v50, v48, v49
v_lshlrev_b32 v51, 16, v50
v_and_b32 v52, 0xffff0000, v50
v_fma_f32 v48, -v51, v8, v48
v_fma_f32 v49, -v52, v8, v49
v_cvt_pk_bf16_f32 v50, v48, v48
v_cvt_pk_bf16_f32 v51, v49, v49
v_and_b32 v24, v50, v4
v_and_b32 v25, v50, v5
v_and_b32 v26, v50, v6
v_and_b32 v27, v50, v7
v_and_b32 v28, v51, v4
v_and_b32 v29, v51, v5
v_and_b32 v30, v51, v6
v_and_b32 v31, v51, v7
s_waitcnt vmcnt(5)
buffer_load_dwordx4 v[80:83], v2, s[32:35], s36 offen offset:1024 nt
buffer_load_dwordx4 v[84:87], v2, s[32:35], s36 offen offset:1280 nt
s_cmp_eq_u32 s34, 0
s_cbranch_scc1 L_nobar3
s_barrier
L_nobar3:
ds_read_b32 v10, v3 offset:512
s_add_u32 s37, s37, 1
v_mfma_f32_16x16x32_bf16 v[16:19], v[56:59], v[24:27], v[16:19]
v_mfma_f32_16x16x32_bf16 v[20:23], v[60:63], v[24:27], v[20:23]
s_waitcnt lgkmcnt(0)
v_readfirstlane_b32 s43, v10
s_cmp_gt_u32 s37, 1100
s_cselect_b32 s34, 0, s34
s_cmp_lt_u32 s43, 128
s_cselect_b32 s34, s34, 0
s_mov_b32 s38, s34
s_min_u32 s43, s43, 127
s_lshr_b32 s36, s43, 5
s_lshl_b32 s36, s36, 2
s_and_b32 s57, s43, 3
s_add_u32 s36, s36, s57
s_lshl_b32 s36, s36, 14
s_bfe_u32 s57, s43, 0x30002
s_lshl_b32 s57, s57, 21
s_add_u32 s36, s36, s57
s_add_u32 s36, s36, s41
s_lshl_b32 s43, s43, 6
s_add_u32 s43, s43, s52
buffer_load_dword v54, v53, s[48:51], s43 offen sc1
s_waitcnt vmcnt(6)
buffer_load_dwordx4 v[56:59], v2, s[32:35], s36 offen offset:0 nt
buffer_load_dwordx4 v[60:63], v2, s[32:35], s36 offen offset:256 nt
v_mfma_f32_16x16x32_bf16 v[16:19], v[64:67], v[28:31], v[16:19]
v_mfma_f32_16x16x32_bf16 v[20:23], v[68:71], v[28:31], v[20:23]
s_cmp_eq_u32 s39, 0
s_nop 5
s_cbranch_scc1 L_sdone
s_waitcnt vmcnt(7)
v_lshlrev_b32 v48, 16, v55
v_and_b32 v49, 0xffff0000, v55
v_sub_f32 v48, v48, v9
v_sub_f32 v49, v49, v9
v_mul_f32 v48, s40, v48
v_mul_f32 v49, s40, v49
v_exp_f32 v48, v48
v_exp_f32 v49, v49
s_nop 0
v_cvt_pk_bf16_f32 v50, v48, v49
v_lshlrev_b32 v51, 16, v50
v_and_b32 v52, 0xffff0000, v50
v_fma_f32 v48, -v51, v8, v48
v_fma_f32 v49, -v52, v8, v49
v_cvt_pk_bf16_f32 v50, v48, v48
v_cvt_pk_bf16_f32 v51, v49, v49
v_and_b32 v24, v50, v4
v_and_b32 v25, v50, v5
v_and_b32 v26, v50, v6
v_and_b32 v27, v50, v7
v_and_b32 v28, v51, v4
v_and_b32 v29, v51, v5
v_and_b32 v30, v51, v6
v_and_b32 v31, v51, v7
s_waitcnt vmcnt(5)
buffer_load_dwordx4 v[64:67], v2, s[32:35], s36 offen offset:1024 nt
buffer_load_dwordx4 v[68:71], v2, s[32:35], s36 offen offset:1280 nt
s_cmp_eq_u32 s34, 0
s_cbranch_scc1 L_nobar4
s_barrier
L_nobar4:
ds_read_b32 v10, v3 offset:516
s_add_u32 s37, s37, 1
v_mfma_f32_16x16x32_bf16 v[16:19], v[72:75], v[24:27], v[16:19]
v_mfma_f32_16x16x32_bf16 v[20:23], v[76:79], v[24:27], v[20:23]
s_waitcnt lgkmcnt(0)
v_readfirstlane_b32 s43, v10
s_cmp_gt_u32 s37, 1100
s_cselect_b32 s34, 0, s34
s_cmp_lt_u32 s43, 128
s_cselect_b32 s34, s34, 0
s_mov_b32 s39, s34
s_min_u32 s43, s43, 127
s_lshr_b32 s36, s43, 5
s_lshl_b32 s36, s36, 2
s_and_b32 s57, s43, 3
s_add_u32 s36, s36, s57
s_lshl_b32 s36, s36, 14
s_bfe_u32 s57, s43, 0x30002
s_lshl_b32 s57, s57, 21
s_add_u32 s36, s36, s57
s_add_u32 s36, s36, s41
s_lshl_b32 s43, s43, 6
s_add_u32 s43, s43, s52
buffer_load_dword v55, v53, s[48:51], s43 offen sc1
s_waitcnt vmcnt(6)
buffer_load_dwordx4 v[72:75], v2, s[32:35], s36 offen offset:0 nt
buffer_load_dwordx4 v[76:79], v2, s[32:35], s36 offen offset:256 nt
v_mfma_f32_16x16x32_bf16 v[16:19], v[80:83], v[28:31], v[16:19]
v_mfma_f32_16x16x32_bf16 v[20:23], v[84:87], v[28:31], v[20:23]
s_nop 6
s_branch L_loop3
L_sdone:
v_add_f32_dpp v16, v16, v16 row_ror:8 row_mask:0xf bank_mask:0xf
v_add_f32_dpp v17, v17, v17 row_ror:8 row_mask:0xf bank_mask:0xf
v_add_f32_dpp v18, v18, v18 row_ror:8 row_mask:0xf bank_mask:0xf
v_add_f32_dpp v19, v19, v19 row_ror:8 row_mask:0xf bank_mask:0xf
v_add_f32_dpp v20, v20, v20 row_ror:8 row_mask:0xf bank_mask:0xf
v_add_f32_dpp v21, v21, v21 row_ror:8 row_mask:0xf bank_mask:0xf
v_add_f32_dpp v22, v22, v22 row_ror:8 row_mask:0xf bank_mask:0xf
v_add_f32_dpp v23, v23, v23 row_ror:8 row_mask:0xf bank_mask:0xf
v_cndmask_b32 v16, v16, v20, s[46:47]
v_cndmask_b32 v17, v17, v21, s[46:47]
v_cndmask_b32 v18, v18, v22, s[46:47]
v_cndmask_b32 v19, v19, v23, s[46:47]
ds_write_b128 v11, v[16:19] offset:1024
s_waitcnt lgkmcnt(0)
s_barrier
s_endpgm
L_helper:
s_setprio 3
s_lshr_b32 s62, s2, 5
s_lshl_b32 s62, s62, 3
s_and_b32 s42, s2, 7
s_add_u32 s62, s62, s42
s_lshl_b32 s62, s62, 2
s_bfe_u32 s43, s2, 0x20003
s_add_u32 s62, s62, s43
v_lshrrev_b32 v4, 1, v0
v_lshlrev_b32 v1, 1, v4
v_and_b32 v5, 1, v0
v_lshlrev_b32 v2, 13, v4
v_lshl_add_u32 v2, v5, 4, v2
v_lshlrev_b32 v3, 4, v0
v_lshrrev_b32 v7, 4, v0
v_lshl_add_u32 v4, v5, 2, v7
v_lshlrev_b32 v4, 3, v4
v_mov_b32 v10, 0
v_mov_b32 v11, 0
v_mov_b32 v12, 0
v_mov_b32 v13, 0
v_mov_b32 v14, 0
v_mov_b32 v15, 0
v_mov_b32 v16, 0
v_mov_b32 v17, 0
v_mov_b32 v18, 0
v_mov_b32 v19, 0
v_mov_b32 v20, 0
v_mov_b32 v21, 0
v_mov_b32 v22, 0
v_mov_b32 v23, 0
v_mov_b32 v70, -1
v_mov_b32 v71, -1
v_mov_b32 v72, -1
v_mov_b32 v73, -1
s_lshr_b32 s89, s61, 3
s_lshl_b32 s43, s60, 1
s_add_u32 s90, s43, s89
s_and_b32 s43, s60, 3
s_lshl_b32 s43, s43, 1
s_add_u32 s43, s43, 1
s_xor_b32 s43, s43, s42
s_cmp_ge_u32 s90, 28
s_cselect_b32 s43, 1, s43
s_cmp_eq_u32 s43, 0
s_cselect_b32 s41, 2, 0
s_cselect_b32 s57, s90, 0
s_mul_i32 s94, s60, 14
s_add_u32 s94, s94, s61
s_sub_u32 s94, s94, s89
s_cmp_eq_u32 s42, 7
s_cselect_b32 s94, 224, s94
s_lshl_b32 s95, s94, 8
s_add_u32 s95, s95, 393216
s_lshl_b32 s56, s90, 13
s_add_u32 s56, s56, 524288
s_add_u32 s92, s56, 4096
s_lshl_b32 s43, s60, 3
s_lshr_b32 s93, s61, 1
s_add_u32 s93, s93, s43
s_lshl_b32 s58, s93, 11
s_add_u32 s58, s58, 65536
s_lshl_b32 s54, s60, 8
s_add_u32 s54, s54, 786432
s_lshl_b32 s42, s2, 7
s_add_u32 s42, s42, 819200
v_cmp_eq_u32 vcc, 2, v0
v_lshl_add_u32 v65, v0, 2, s42
v_mov_b32 v63, s54
v_cndmask_b32 v65, v65, v63, vcc
v_cndmask_b32 v64, -1, 0, vcc
s_waitcnt lgkmcnt(0)
s_mov_b32 s28, s4
s_mov_b32 s29, s5
s_mov_b32 s30, 900
s_mov_b32 s31, 0x00020000
s_mov_b32 s32, s10
s_mov_b32 s33, s11
s_mov_b32 s34, 3670016
s_mov_b32 s35, 0x00020000
s_mov_b32 s36, s26
s_mov_b32 s37, s27
s_mov_b32 s38, 0x120000
s_mov_b32 s39, 0x00020000
s_lshl_b32 s63, s62, 6
buffer_load_dword v5, v4, s[36:39], s63 offen offset:4 sc1
s_lshl_b32 s59, s60, 10
buffer_load_dwordx4 v[74:77], v3, s[36:39], s59 offen offset:0 sc1
s_bitcmp1_b32 s61, 0
s_cbranch_scc1 L_cl1
buffer_store_dwordx4 v[70:73], v3, s[36:39], s58 offen offset:0 sc1
buffer_store_dwordx4 v[70:73], v3, s[36:39], s58 offen offset:1024 sc1
L_cl1:
s_cmp_lg_u32 s41, 2
s_cbranch_scc1 L_cl2
buffer_store_dwordx4 v[70:73], v3, s[36:39], s56 offen offset:0 sc1
buffer_store_dwordx4 v[70:73], v3, s[36:39], s56 offen offset:1024 sc1
buffer_store_dwordx4 v[70:73], v3, s[36:39], s56 offen offset:2048 sc1
buffer_store_dwordx4 v[70:73], v3, s[36:39], s56 offen offset:3072 sc1
buffer_store_dwordx4 v[70:73], v3, s[36:39], s92 offen offset:0 sc1
buffer_store_dwordx4 v[70:73], v3, s[36:39], s92 offen offset:1024 sc1
buffer_store_dwordx4 v[70:73], v3, s[36:39], s92 offen offset:2048 sc1
buffer_store_dwordx4 v[70:73], v3, s[36:39], s92 offen offset:3072 sc1
L_cl2:
s_mov_b64 exec, 0xffff
buffer_store_dwordx4 v[70:73], v3, s[36:39], s95 offen sc1
s_cmp_eq_u32 s61, 0
s_cselect_b32 exec_lo, 7, 3
s_mov_b32 exec_hi, 0
buffer_store_dword v64, v65, s[36:39], 0 offen sc1
s_mov_b64 exec, -1
buffer_load_short_d16_hi v10, v1, s[28:31], 0 offen offset:0
buffer_load_short_d16_hi v11, v1, s[28:31], 0 offen offset:64
buffer_load_short_d16_hi v12, v1, s[28:31], 0 offen offset:128
buffer_load_short_d16_hi v13, v1, s[28:31], 0 offen offset:192
buffer_load_short_d16_hi v14, v1, s[28:31], 0 offen offset:256
buffer_load_short_d16_hi v15, v1, s[28:31], 0 offen offset:320
buffer_load_short_d16_hi v16, v1, s[28:31], 0 offen offset:384
buffer_load_short_d16_hi v17, v1, s[28:31], 0 offen offset:448
buffer_load_short_d16_hi v18, v1, s[28:31], 0 offen offset:512
buffer_load_short_d16_hi v19, v1, s[28:31], 0 offen offset:576
buffer_load_short_d16_hi v20, v1, s[28:31], 0 offen offset:640
buffer_load_short_d16_hi v21, v1, s[28:31], 0 offen offset:704
buffer_load_short_d16_hi v22, v1, s[28:31], 0 offen offset:768
buffer_load_short_d16_hi v23, v1, s[28:31], 0 offen offset:832
s_lshl_b32 s43, s62, 5
buffer_load_dwordx4 v[112:115], v2, s[32:35], s43 offen nt
s_add_u32 s43, s43, 262144
buffer_load_dwordx4 v[116:119], v2, s[32:35], s43 offen nt
s_add_u32 s43, s43, 262144
buffer_load_dwordx4 v[120:123], v2, s[32:35], s43 offen nt
s_add_u32 s43, s43, 262144
buffer_load_dwordx4 v[124:127], v2, s[32:35], s43 offen nt
s_add_u32 s43, s43, 262144
buffer_load_dwordx4 v[128:131], v2, s[32:35], s43 offen nt
s_add_u32 s43, s43, 262144
buffer_load_dwordx4 v[132:135], v2, s[32:35], s43 offen nt
s_add_u32 s43, s43, 262144
buffer_load_dwordx4 v[136:139], v2, s[32:35], s43 offen nt
s_add_u32 s43, s43, 262144
buffer_load_dwordx4 v[140:143], v2, s[32:35], s43 offen nt
s_add_u32 s43, s43, 262144
buffer_load_dwordx4 v[144:147], v2, s[32:35], s43 offen nt
s_add_u32 s43, s43, 262144
buffer_load_dwordx4 v[148:151], v2, s[32:35], s43 offen nt
s_add_u32 s43, s43, 262144
buffer_load_dwordx4 v[152:155], v2, s[32:35], s43 offen nt
s_add_u32 s43, s43, 262144
buffer_load_dwordx4 v[156:159], v2, s[32:35], s43 offen nt
s_add_u32 s43, s43, 262144
buffer_load_dwordx4 v[160:163], v2, s[32:35], s43 offen nt
s_add_u32 s43, s43, 262144
buffer_load_dwordx4 v[164:167], v2, s[32:35], s43 offen nt
s_barrier
v_and_b32 v58, 1, v0
v_cmp_eq_u32 vcc, 1, v58
v_mov_b32 v58, 0xffff
v_mov_b32 v59, 0xffff0000
v_cndmask_b32 v58, v58, v59, vcc
v_bfe_u32 v59, v0, 1, 2
v_cmp_eq_u32 vcc, 0, v59
s_nop 1
v_cndmask_b32 v38, 0, v58, vcc
v_cmp_eq_u32 vcc, 1, v59
s_nop 1
v_cndmask_b32 v39, 0, v58, vcc
v_cmp_eq_u32 vcc, 2, v59
s_nop 1
v_cndmask_b32 v40, 0, v58, vcc
v_cmp_eq_u32 vcc, 3, v59
s_nop 1
v_cndmask_b32 v41, 0, v58, vcc
s_waitcnt vmcnt(14)
v_add_f32 v58, v10, v11
v_add_f32 v59, v12, v13
v_add_f32 v58, v58, v14
v_add_f32 v59, v59, v15
v_add_f32 v58, v58, v16
v_add_f32 v59, v59, v17
v_add_f32 v58, v58, v18
v_add_f32 v59, v59, v19
v_add_f32 v58, v58, v20
v_add_f32 v59, v59, v21
v_add_f32 v58, v58, v22
v_add_f32 v59, v59, v23
v_add_f32 v58, v58, v59
s_nop 1
v_add_f32_dpp v58, v58, v58 quad_perm:[2,3,0,1] row_mask:0xf bank_mask:0xf
s_nop 1
v_add_f32_dpp v58, v58, v58 row_ror:4 row_mask:0xf bank_mask:0xf
s_nop 1
v_add_f32_dpp v58, v58, v58 row_ror:8 row_mask:0xf bank_mask:0xf
v_mov_b32 v59, v58
s_nop 1
v_permlane16_swap_b32 v58, v59
v_add_f32 v58, v58, v59
v_mov_b32 v59, v58
s_nop 1
v_permlane32_swap_b32 v58, v59
v_add_f32 v58, v58, v59
v_mul_f32 v58, 0x3b124925, v58
v_sub_f32 v24, v10, v58
v_sub_f32 v25, v11, v58
v_sub_f32 v26, v12, v58
v_sub_f32 v27, v13, v58
v_sub_f32 v28, v14, v58
v_sub_f32 v29, v15, v58
v_sub_f32 v30, v16, v58
v_sub_f32 v31, v17, v58
v_sub_f32 v32, v18, v58
v_sub_f32 v33, v19, v58
v_sub_f32 v34, v20, v58
v_sub_f32 v35, v21, v58
v_sub_f32 v36, v22, v58
v_sub_f32 v37, v23, v58
v_mul_f32 v59, v24, v24
v_mul_f32 v60, v25, v25
v_fmac_f32 v59, v26, v26
v_fmac_f32 v60, v27, v27
v_fmac_f32 v59, v28, v28
v_fmac_f32 v60, v29, v29
v_fmac_f32 v59, v30, v30
v_fmac_f32 v60, v31, v31
v_fmac_f32 v59, v32, v32
v_fmac_f32 v60, v33, v33
v_fmac_f32 v59, v34, v34
v_fmac_f32 v60, v35, v35
v_fmac_f32 v59, v36, v36
v_fmac_f32 v60, v37, v37
v_add_f32 v59, v59, v60
s_nop 1
v_add_f32_dpp v59, v59, v59 quad_perm:[2,3,0,1] row_mask:0xf bank_mask:0xf
s_nop 1
v_add_f32_dpp v59, v59, v59 row_ror:4 row_mask:0xf bank_mask:0xf
s_nop 1
v_add_f32_dpp v59, v59, v59 row_ror:8 row_mask:0xf bank_mask:0xf
v_mov_b32 v60, v59
s_nop 1
v_permlane16_swap_b32 v59, v60
v_add_f32 v59, v59, v60
v_mov_b32 v60, v59
s_nop 1
v_permlane32_swap_b32 v59, v60
v_add_f32 v59, v59, v60
v_mul_f32 v59, 0x3b124925, v59
v_cvt_pk_bf16_f32 v60, v58, v59
v_lshlrev_b32 v58, 16, v60
v_and_b32 v59, 0xffff0000, v60
v_add_f32 v59, 0x3727c5ac, v59
v_cvt_pk_bf16_f32 v59, v59, v59
v_and_b32 v59, 0xffff0000, v59
v_sqrt_f32 v59, v59
s_nop 0
v_cvt_pk_bf16_f32 v59, v59, v59
v_and_b32 v59, 0xffff0000, v59
v_rcp_f32 v59, v59
v_sub_f32 v10, v10, v58
v_sub_f32 v11, v11, v58
v_cvt_pk_bf16_f32 v60, v10, v11
v_lshlrev_b32 v10, 16, v60
v_and_b32 v11, 0xffff0000, v60
v_mul_f32 v10, v10, v59
v_mul_f32 v11, v11, v59
v_cvt_pk_bf16_f32 v60, v10, v11
v_lshlrev_b32 v10, 16, v60
v_and_b32 v11, 0xffff0000, v60
v_and_b32 v24, 0xffff, v60
v_lshrrev_b32 v25, 16, v60
v_sub_f32 v12, v12, v58
v_sub_f32 v13, v13, v58
v_cvt_pk_bf16_f32 v60, v12, v13
v_lshlrev_b32 v12, 16, v60
v_and_b32 v13, 0xffff0000, v60
v_mul_f32 v12, v12, v59
v_mul_f32 v13, v13, v59
v_cvt_pk_bf16_f32 v60, v12, v13
v_lshlrev_b32 v12, 16, v60
v_and_b32 v13, 0xffff0000, v60
v_and_b32 v26, 0xffff, v60
v_lshrrev_b32 v27, 16, v60
v_sub_f32 v14, v14, v58
v_sub_f32 v15, v15, v58
v_cvt_pk_bf16_f32 v60, v14, v15
v_lshlrev_b32 v14, 16, v60
v_and_b32 v15, 0xffff0000, v60
v_mul_f32 v14, v14, v59
v_mul_f32 v15, v15, v59
v_cvt_pk_bf16_f32 v60, v14, v15
v_lshlrev_b32 v14, 16, v60
v_and_b32 v15, 0xffff0000, v60
v_and_b32 v28, 0xffff, v60
v_lshrrev_b32 v29, 16, v60
v_sub_f32 v16, v16, v58
v_sub_f32 v17, v17, v58
v_cvt_pk_bf16_f32 v60, v16, v17
v_lshlrev_b32 v16, 16, v60
v_and_b32 v17, 0xffff0000, v60
v_mul_f32 v16, v16, v59
v_mul_f32 v17, v17, v59
v_cvt_pk_bf16_f32 v60, v16, v17
v_lshlrev_b32 v16, 16, v60
v_and_b32 v17, 0xffff0000, v60
v_and_b32 v30, 0xffff, v60
v_lshrrev_b32 v31, 16, v60
v_sub_f32 v18, v18, v58
v_sub_f32 v19, v19, v58
v_cvt_pk_bf16_f32 v60, v18, v19
v_lshlrev_b32 v18, 16, v60
v_and_b32 v19, 0xffff0000, v60
v_mul_f32 v18, v18, v59
v_mul_f32 v19, v19, v59
v_cvt_pk_bf16_f32 v60, v18, v19
v_lshlrev_b32 v18, 16, v60
v_and_b32 v19, 0xffff0000, v60
v_and_b32 v32, 0xffff, v60
v_lshrrev_b32 v33, 16, v60
v_sub_f32 v20, v20, v58
v_sub_f32 v21, v21, v58
v_cvt_pk_bf16_f32 v60, v20, v21
v_lshlrev_b32 v20, 16, v60
v_and_b32 v21, 0xffff0000, v60
v_mul_f32 v20, v20, v59
v_mul_f32 v21, v21, v59
v_cvt_pk_bf16_f32 v60, v20, v21
v_lshlrev_b32 v20, 16, v60
v_and_b32 v21, 0xffff0000, v60
v_and_b32 v34, 0xffff, v60
v_lshrrev_b32 v35, 16, v60
v_sub_f32 v22, v22, v58
v_sub_f32 v23, v23, v58
v_cvt_pk_bf16_f32 v60, v22, v23
v_lshlrev_b32 v22, 16, v60
v_and_b32 v23, 0xffff0000, v60
v_mul_f32 v22, v22, v59
v_mul_f32 v23, v23, v59
v_cvt_pk_bf16_f32 v60, v22, v23
v_lshlrev_b32 v22, 16, v60
v_and_b32 v23, 0xffff0000, v60
v_and_b32 v36, 0xffff, v60
v_lshrrev_b32 v37, 16, v60
s_waitcnt vmcnt(13)
v_dot2_f32_bf16 v42, v112, v24, 0
v_dot2_f32_bf16 v43, v112, v10, 0
v_dot2_f32_bf16 v44, v113, v24, 0
v_dot2_f32_bf16 v45, v113, v10, 0
v_dot2_f32_bf16 v46, v114, v24, 0
v_dot2_f32_bf16 v47, v114, v10, 0
v_dot2_f32_bf16 v48, v115, v24, 0
v_dot2_f32_bf16 v49, v115, v10, 0
s_waitcnt vmcnt(12)
v_dot2_f32_bf16 v42, v116, v25, v42
v_dot2_f32_bf16 v43, v116, v11, v43
v_dot2_f32_bf16 v44, v117, v25, v44
v_dot2_f32_bf16 v45, v117, v11, v45
v_dot2_f32_bf16 v46, v118, v25, v46
v_dot2_f32_bf16 v47, v118, v11, v47
v_dot2_f32_bf16 v48, v119, v25, v48
v_dot2_f32_bf16 v49, v119, v11, v49
s_waitcnt vmcnt(11)
v_dot2_f32_bf16 v42, v120, v26, v42
v_dot2_f32_bf16 v43, v120, v12, v43
v_dot2_f32_bf16 v44, v121, v26, v44
v_dot2_f32_bf16 v45, v121, v12, v45
v_dot2_f32_bf16 v46, v122, v26, v46
v_dot2_f32_bf16 v47, v122, v12, v47
v_dot2_f32_bf16 v48, v123, v26, v48
v_dot2_f32_bf16 v49, v123, v12, v49
s_waitcnt vmcnt(10)
v_dot2_f32_bf16 v42, v124, v27, v42
v_dot2_f32_bf16 v43, v124, v13, v43
v_dot2_f32_bf16 v44, v125, v27, v44
v_dot2_f32_bf16 v45, v125, v13, v45
v_dot2_f32_bf16 v46, v126, v27, v46
v_dot2_f32_bf16 v47, v126, v13, v47
v_dot2_f32_bf16 v48, v127, v27, v48
v_dot2_f32_bf16 v49, v127, v13, v49
s_waitcnt vmcnt(9)
v_dot2_f32_bf16 v42, v128, v28, v42
v_dot2_f32_bf16 v43, v128, v14, v43
v_dot2_f32_bf16 v44, v129, v28, v44
v_dot2_f32_bf16 v45, v129, v14, v45
v_dot2_f32_bf16 v46, v130, v28, v46
v_dot2_f32_bf16 v47, v130, v14, v47
v_dot2_f32_bf16 v48, v131, v28, v48
v_dot2_f32_bf16 v49, v131, v14, v49
s_waitcnt vmcnt(8)
v_dot2_f32_bf16 v42, v132, v29, v42
v_dot2_f32_bf16 v43, v132, v15, v43
v_dot2_f32_bf16 v44, v133, v29, v44
v_dot2_f32_bf16 v45, v133, v15, v45
v_dot2_f32_bf16 v46, v134, v29, v46
v_dot2_f32_bf16 v47, v134, v15, v47
v_dot2_f32_bf16 v48, v135, v29, v48
v_dot2_f32_bf16 v49, v135, v15, v49
s_waitcnt vmcnt(7)
v_dot2_f32_bf16 v42, v136, v30, v42
v_dot2_f32_bf16 v43, v136, v16, v43
v_dot2_f32_bf16 v44, v137, v30, v44
v_dot2_f32_bf16 v45, v137, v16, v45
v_dot2_f32_bf16 v46, v138, v30, v46
v_dot2_f32_bf16 v47, v138, v16, v47
v_dot2_f32_bf16 v48, v139, v30, v48
v_dot2_f32_bf16 v49, v139, v16, v49
s_waitcnt vmcnt(6)
v_dot2_f32_bf16 v42, v140, v31, v42
v_dot2_f32_bf16 v43, v140, v17, v43
v_dot2_f32_bf16 v44, v141, v31, v44
v_dot2_f32_bf16 v45, v141, v17, v45
v_dot2_f32_bf16 v46, v142, v31, v46
v_dot2_f32_bf16 v47, v142, v17, v47
v_dot2_f32_bf16 v48, v143, v31, v48
v_dot2_f32_bf16 v49, v143, v17, v49
s_waitcnt vmcnt(5)
v_dot2_f32_bf16 v42, v144, v32, v42
v_dot2_f32_bf16 v43, v144, v18, v43
v_dot2_f32_bf16 v44, v145, v32, v44
v_dot2_f32_bf16 v45, v145, v18, v45
v_dot2_f32_bf16 v46, v146, v32, v46
v_dot2_f32_bf16 v47, v146, v18, v47
v_dot2_f32_bf16 v48, v147, v32, v48
v_dot2_f32_bf16 v49, v147, v18, v49
s_waitcnt vmcnt(4)
v_dot2_f32_bf16 v42, v148, v33, v42
v_dot2_f32_bf16 v43, v148, v19, v43
v_dot2_f32_bf16 v44, v149, v33, v44
v_dot2_f32_bf16 v45, v149, v19, v45
v_dot2_f32_bf16 v46, v150, v33, v46
v_dot2_f32_bf16 v47, v150, v19, v47
v_dot2_f32_bf16 v48, v151, v33, v48
v_dot2_f32_bf16 v49, v151, v19, v49
s_waitcnt vmcnt(3)
v_dot2_f32_bf16 v42, v152, v34, v42
v_dot2_f32_bf16 v43, v152, v20, v43
v_dot2_f32_bf16 v44, v153, v34, v44
v_dot2_f32_bf16 v45, v153, v20, v45
v_dot2_f32_bf16 v46, v154, v34, v46
v_dot2_f32_bf16 v47, v154, v20, v47
v_dot2_f32_bf16 v48, v155, v34, v48
v_dot2_f32_bf16 v49, v155, v20, v49
s_waitcnt vmcnt(2)
v_dot2_f32_bf16 v42, v156, v35, v42
v_dot2_f32_bf16 v43, v156, v21, v43
v_dot2_f32_bf16 v44, v157, v35, v44
v_dot2_f32_bf16 v45, v157, v21, v45
v_dot2_f32_bf16 v46, v158, v35, v46
v_dot2_f32_bf16 v47, v158, v21, v47
v_dot2_f32_bf16 v48, v159, v35, v48
v_dot2_f32_bf16 v49, v159, v21, v49
s_waitcnt vmcnt(1)
v_dot2_f32_bf16 v42, v160, v36, v42
v_dot2_f32_bf16 v43, v160, v22, v43
v_dot2_f32_bf16 v44, v161, v36, v44
v_dot2_f32_bf16 v45, v161, v22, v45
v_dot2_f32_bf16 v46, v162, v36, v46
v_dot2_f32_bf16 v47, v162, v22, v47
v_dot2_f32_bf16 v48, v163, v36, v48
v_dot2_f32_bf16 v49, v163, v22, v49
s_waitcnt vmcnt(0)
v_dot2_f32_bf16 v42, v164, v37, v42
v_dot2_f32_bf16 v43, v164, v23, v43
v_dot2_f32_bf16 v44, v165, v37, v44
v_dot2_f32_bf16 v45, v165, v23, v45
v_dot2_f32_bf16 v46, v166, v37, v46
v_dot2_f32_bf16 v47, v166, v23, v47
v_dot2_f32_bf16 v48, v167, v37, v48
v_dot2_f32_bf16 v49, v167, v23, v49
v_permlane32_swap_b32 v42, v46
s_nop 0
v_permlane32_swap_b32 v44, v48
v_add_f32 v42, v42, v46
v_add_f32 v44, v44, v48
s_nop 1
v_permlane16_swap_b32 v42, v44
v_add_f32 v42, v42, v44
v_permlane32_swap_b32 v43, v47
v_permlane32_swap_b32 v45, v49
v_add_f32 v43, v43, v47
v_add_f32 v45, v45, v49
s_nop 1
v_permlane16_swap_b32 v43, v45
v_add_f32 v43, v43, v45
v_add_f32_dpp v42, v42, v42 quad_perm:[2,3,0,1] row_mask:0xf bank_mask:0xf
s_nop 0
v_add_f32_dpp v43, v43, v43 quad_perm:[2,3,0,1] row_mask:0xf bank_mask:0xf
v_add_f32_dpp v42, v42, v42 row_ror:4 row_mask:0xf bank_mask:0xf
s_nop 0
v_add_f32_dpp v43, v43, v43 row_ror:4 row_mask:0xf bank_mask:0xf
v_add_f32_dpp v42, v42, v42 row_ror:8 row_mask:0xf bank_mask:0xf
s_nop 0
v_add_f32_dpp v43, v43, v43 row_ror:8 row_mask:0xf bank_mask:0xf
v_cvt_pk_bf16_f32 v58, v42, v43
v_add_u32 v59, 1, v5
v_add_u32 v8, 1, v75
v_add_u32 v9, 1, v77
s_mov_b32 exec_lo, 0x30003
s_mov_b32 exec_hi, 0x30003
buffer_store_dwordx2 v[58:59], v4, s[36:39], s63 offen offset:0 sc1
s_mov_b64 exec, -1
s_mov_b32 s44, s24
s_mov_b32 s45, s25
s_mov_b32 s46, 256
s_mov_b32 s47, 0x00020000
s_mov_b32 s53, 0
s_mov_b32 s87, 0
L_qpoll:
buffer_load_dwordx4 v[74:77], v3, s[36:39], s59 offen offset:0 sc1
s_add_u32 s53, s53, 1
s_cmp_gt_u32 s53, 32
s_cbranch_scc1 L_qself
s_waitcnt vmcnt(0)
v_cmp_ne_u32 vcc, v8, v75
v_cmp_ne_u32 s[48:49], v9, v77
s_nop 0
s_or_b64 vcc, vcc, s[48:49]
s_nop 1
s_cbranch_vccnz L_qpoll
v_mov_b32 v75, v76
v_lshlrev_b32 v58, 3, v0
ds_write_b64 v58, v[74:75]
s_cmp_lg_u32 s61, 0
s_cbranch_scc1 L_qok
s_lshl_b32 s43, s60, 2
v_mov_b32 v58, s43
v_mov_b32 v59, 1
s_mov_b64 exec, 1
buffer_store_dword v59, v58, s[44:47], 0 offen sc1
s_mov_b64 exec, -1
L_qok:
v_lshlrev_b32 v58, 2, v0
s_mov_b64 exec, 31
ds_write_b32 v58, v70 offset:656
s_mov_b64 exec, -1
s_waitcnt lgkmcnt(0)
s_barrier
v_and_b32 v5, 15, v0
v_lshlrev_b32 v5, 4, v5
s_mov_b32 s50, 0xff00ff00
s_mov_b32 s51, 0xff00ff00
v_mov_b32 v94, 0
v_mov_b32 v95, 0
v_mov_b32 v96, 0
v_mov_b32 v97, 0
v_mov_b32 v98, 0
v_mov_b32 v99, 0
v_mov_b32 v100, 0
v_mov_b32 v101, 0
v_mov_b32 v102, 0
v_mov_b32 v103, 0
v_mov_b32 v104, 0
v_mov_b32 v105, 0
v_mov_b32 v106, 0
v_mov_b32 v107, 0
v_mov_b32 v108, 0
v_mov_b32 v109, 0
v_lshlrev_b32 v58, 1, v1
ds_write_b32 v58, v10 offset:9728
ds_write_b32 v58, v11 offset:9856
ds_write_b32 v58, v12 offset:9984
ds_write_b32 v58, v13 offset:10112
ds_write_b32 v58, v14 offset:10240
ds_write_b32 v58, v15 offset:10368
ds_write_b32 v58, v16 offset:10496
ds_write_b32 v58, v17 offset:10624
ds_write_b32 v58, v18 offset:10752
ds_write_b32 v58, v19 offset:10880
ds_write_b32 v58, v20 offset:11008
ds_write_b32 v58, v21 offset:11136
ds_write_b32 v58, v22 offset:11264
ds_write_b32 v58, v23 offset:11392
s_waitcnt lgkmcnt(0)
s_mov_b32 s53, 0
v_and_b32 v59, 3, v0
v_lshlrev_b32 v59, 2, v59
L_wmid:
ds_read_b32 v58, v59 offset:656
s_waitcnt lgkmcnt(0)
v_cmp_eq_u32 vcc, -1, v58
s_nop 0
s_cbranch_vccz L_wmid_ok
s_sleep 4
s_add_u32 s53, s53, 1
s_cmp_ge_u32 s53, 1048576
s_cbranch_scc1 L_end
s_branch L_wmid
L_wmid_ok:
s_cmp_eq_u32 s94, 224
s_cbranch_scc1 L_f1
s_cmp_ge_u32 s94, 112
s_cselect_b32 s32, s18, s16
s_cselect_b32 s33, s19, s17
s_cselect_b32 s43, 112, 0
s_mov_b32 s34, 1605632
s_mov_b32 s35, 0x00020000
s_sub_u32 s43, s94, s43
s_and_b32 s52, s43, 3
s_lshr_b32 s43, s43, 2
s_lshl_b32 s43, s43, 7
s_mul_i32 s88, s52, 401408
s_add_u32 s43, s43, s88
s_mul_i32 s52, s52, 448
v_lshrrev_b32 v59, 3, v0
v_mul_u32_u24 v6, 3584, v59
v_and_b32 v58, 7, v0
v_lshl_add_u32 v6, v58, 4, v6
v_lshl_add_u32 v59, v59, 2, s52
buffer_load_dwordx4 v[176:179], v6, s[32:35], s43 offen nt
s_add_u32 s43, s43, 28672
buffer_load_dwordx4 v[180:183], v6, s[32:35], s43 offen nt
s_add_u32 s43, s43, 28672
buffer_load_dwordx4 v[184:187], v6, s[32:35], s43 offen nt
s_add_u32 s43, s43, 28672
buffer_load_dwordx4 v[188:191], v6, s[32:35], s43 offen nt
s_add_u32 s43, s43, 28672
buffer_load_dwordx4 v[192:195], v6, s[32:35], s43 offen nt
s_add_u32 s43, s43, 28672
buffer_load_dwordx4 v[196:199], v6, s[32:35], s43 offen nt
s_add_u32 s43, s43, 28672
buffer_load_dwordx4 v[200:203], v6, s[32:35], s43 offen nt
s_add_u32 s43, s43, 28672
buffer_load_dwordx4 v[204:207], v6, s[32:35], s43 offen nt
s_add_u32 s43, s43, 28672
buffer_load_dwordx4 v[208:211], v6, s[32:35], s43 offen nt
s_add_u32 s43, s43, 28672
buffer_load_dwordx4 v[212:215], v6, s[32:35], s43 offen nt
s_add_u32 s43, s43, 28672
buffer_load_dwordx4 v[216:219], v6, s[32:35], s43 offen nt
s_add_u32 s43, s43, 28672
buffer_load_dwordx4 v[220:223], v6, s[32:35], s43 offen nt
s_add_u32 s43, s43, 28672
buffer_load_dwordx4 v[224:227], v6, s[32:35], s43 offen nt
s_add_u32 s43, s43, 28672
buffer_load_dwordx4 v[228:231], v6, s[32:35], s43 offen nt
ds_read_b32 v10, v59 offset:9728
ds_read_b32 v11, v59 offset:9760
ds_read_b32 v12, v59 offset:9792
ds_read_b32 v13, v59 offset:9824
ds_read_b32 v14, v59 offset:9856
ds_read_b32 v15, v59 offset:9888
ds_read_b32 v16, v59 offset:9920
ds_read_b32 v17, v59 offset:9952
ds_read_b32 v18, v59 offset:9984
ds_read_b32 v19, v59 offset:10016
ds_read_b32 v20, v59 offset:10048
ds_read_b32 v21, v59 offset:10080
ds_read_b32 v22, v59 offset:10112
ds_read_b32 v23, v59 offset:10144
L_f1:
s_bitcmp1_b32 s61, 0
s_cbranch_scc1 L_f2
s_mov_b32 s32, s20
s_mov_b32 s33, s21
s_mov_b32 s34, 1605632
s_mov_b32 s35, 0x00020000
v_mul_u32_u24 v8, 896, v7
v_add_u32 v8, v8, v5
s_mul_i32 s43, s93, 12544
v_mov_b32 v160, 0
v_mov_b32 v161, 0
v_mov_b32 v162, 0
v_mov_b32 v163, 0
v_mov_b32 v164, 0
v_mov_b32 v165, 0
v_mov_b32 v166, 0
v_mov_b32 v167, 0
v_mov_b32 v168, 0
v_mov_b32 v169, 0
v_mov_b32 v170, 0
v_mov_b32 v171, 0
v_mov_b32 v172, 0
v_mov_b32 v173, 0
v_mov_b32 v174, 0
v_mov_b32 v175, 0
buffer_load_dwordx4 v[112:115], v8, s[32:35], s43 offen offset:0 nt
buffer_load_dwordx4 v[116:119], v8, s[32:35], s43 offen offset:256 nt
buffer_load_dwordx4 v[120:123], v8, s[32:35], s43 offen offset:512 nt
s_mov_b32 exec_lo, 0xff00ff
s_mov_b32 exec_hi, 0xff00ff
buffer_load_dwordx4 v[124:127], v8, s[32:35], s43 offen offset:768 nt
s_add_u32 s43, s43, 3584
s_mov_b32 exec_lo, 0xffffffff
s_mov_b32 exec_hi, 0xffffffff
buffer_load_dwordx4 v[128:131], v8, s[32:35], s43 offen offset:0 nt
buffer_load_dwordx4 v[132:135], v8, s[32:35], s43 offen offset:256 nt
buffer_load_dwordx4 v[136:139], v8, s[32:35], s43 offen offset:512 nt
s_mov_b32 exec_lo, 0xff00ff
s_mov_b32 exec_hi, 0xff00ff
buffer_load_dwordx4 v[140:143], v8, s[32:35], s43 offen offset:768 nt
s_add_u32 s43, s43, 3584
s_mov_b32 exec_lo, 0xffffffff
s_mov_b32 exec_hi, 0xffffffff
buffer_load_dwordx4 v[144:147], v8, s[32:35], s43 offen offset:0 nt
buffer_load_dwordx4 v[148:151], v8, s[32:35], s43 offen offset:256 nt
buffer_load_dwordx4 v[152:155], v8, s[32:35], s43 offen offset:512 nt
s_mov_b32 exec_lo, 0xff00ff
s_mov_b32 exec_hi, 0xff00ff
buffer_load_dwordx4 v[156:159], v8, s[32:35], s43 offen offset:768 nt
s_add_u32 s43, s43, 3584
s_mov_b32 exec_lo, 0xffffffff
s_mov_b32 exec_hi, 0x0
buffer_load_dwordx4 v[160:163], v8, s[32:35], s43 offen offset:0 nt
buffer_load_dwordx4 v[164:167], v8, s[32:35], s43 offen offset:256 nt
buffer_load_dwordx4 v[168:171], v8, s[32:35], s43 offen offset:512 nt
s_mov_b32 exec_lo, 0xff00ff
s_mov_b32 exec_hi, 0x0
buffer_load_dwordx4 v[172:175], v8, s[32:35], s43 offen offset:768 nt
s_mov_b64 exec, -1
L_f2:
v_and_b32 v58, 3, v0
v_lshlrev_b32 v58, 10, v58
v_lshrrev_b32 v59, 2, v0
v_lshl_add_u32 v58, v59, 4, v58
v_mov_b32 v1, 0
ds_read_b128 v[42:45], v58 offset:6016
ds_read_b128 v[50:53], v1 offset:656
ds_read_b128 v[78:81], v3 offset:5120
ds_read_b128 v[82:85], v3 offset:6144
ds_read_b128 v[86:89], v3 offset:7168
ds_read_b128 v[90:93], v3 offset:8192
v_and_b32 v58, 7, v0
v_lshlrev_b32 v58, 4, v58
v_lshrrev_b32 v59, 3, v0
v_lshl_add_u32 v58, v59, 11, v58
s_mul_i32 s43, s60, 8192
s_and_b32 s52, s61, 7
s_lshl_b32 s52, s52, 8
s_add_u32 s43, s43, s52
s_lshr_b32 s52, s61, 3
s_lshl_b32 s52, s52, 7
s_add_u32 s43, s43, s52
s_add_u32 s43, s43, 851968
s_waitcnt lgkmcnt(0)
s_mov_b32 exec_lo, 0xffffffff
s_mov_b32 exec_hi, 0x0
buffer_store_dwordx4 v[42:45], v58, s[36:39], s43 offen sc1
s_mov_b64 exec, -1
v_max3_f32 v50, v50, v51, v52
v_max_f32 v50, v50, v53
v_mov_b32 v51, 0
v_mov_b32 v52, 0
v_lshlrev_b32 v58, 16, v78
v_and_b32 v59, 0xffff0000, v78
v_sub_f32 v58, v58, v50
v_sub_f32 v59, v59, v50
v_mul_f32 v58, s40, v58
v_mul_f32 v59, s40, v59
v_exp_f32 v58, v58
v_exp_f32 v59, v59
v_add_f32 v51, v51, v58
v_add_f32 v52, v52, v59
v_lshlrev_b32 v58, 16, v79
v_and_b32 v59, 0xffff0000, v79
v_sub_f32 v58, v58, v50
v_sub_f32 v59, v59, v50
v_mul_f32 v58, s40, v58
v_mul_f32 v59, s40, v59
v_exp_f32 v58, v58
v_exp_f32 v59, v59
v_add_f32 v51, v51, v58
v_add_f32 v52, v52, v59
v_lshlrev_b32 v58, 16, v80
v_and_b32 v59, 0xffff0000, v80
v_sub_f32 v58, v58, v50
v_sub_f32 v59, v59, v50
v_mul_f32 v58, s40, v58
v_mul_f32 v59, s40, v59
v_exp_f32 v58, v58
v_exp_f32 v59, v59
v_add_f32 v51, v51, v58
v_add_f32 v52, v52, v59
v_lshlrev_b32 v58, 16, v81
v_and_b32 v59, 0xffff0000, v81
v_sub_f32 v58, v58, v50
v_sub_f32 v59, v59, v50
v_mul_f32 v58, s40, v58
v_mul_f32 v59, s40, v59
v_exp_f32 v58, v58
v_exp_f32 v59, v59
v_add_f32 v51, v51, v58
v_add_f32 v52, v52, v59
v_lshlrev_b32 v58, 16, v82
v_and_b32 v59, 0xffff0000, v82
v_sub_f32 v58, v58, v50
v_sub_f32 v59, v59, v50
v_mul_f32 v58, s40, v58
v_mul_f32 v59, s40, v59
v_exp_f32 v58, v58
v_exp_f32 v59, v59
v_add_f32 v51, v51, v58
v_add_f32 v52, v52, v59
v_lshlrev_b32 v58, 16, v83
v_and_b32 v59, 0xffff0000, v83
v_sub_f32 v58, v58, v50
v_sub_f32 v59, v59, v50
v_mul_f32 v58, s40, v58
v_mul_f32 v59, s40, v59
v_exp_f32 v58, v58
v_exp_f32 v59, v59
v_add_f32 v51, v51, v58
v_add_f32 v52, v52, v59
v_lshlrev_b32 v58, 16, v84
v_and_b32 v59, 0xffff0000, v84
v_sub_f32 v58, v58, v50
v_sub_f32 v59, v59, v50
v_mul_f32 v58, s40, v58
v_mul_f32 v59, s40, v59
v_exp_f32 v58, v58
v_exp_f32 v59, v59
v_add_f32 v51, v51, v58
v_add_f32 v52, v52, v59
v_lshlrev_b32 v58, 16, v85
v_and_b32 v59, 0xffff0000, v85
v_sub_f32 v58, v58, v50
v_sub_f32 v59, v59, v50
v_mul_f32 v58, s40, v58
v_mul_f32 v59, s40, v59
v_exp_f32 v58, v58
v_exp_f32 v59, v59
v_add_f32 v51, v51, v58
v_add_f32 v52, v52, v59
v_lshlrev_b32 v58, 16, v86
v_and_b32 v59, 0xffff0000, v86
v_sub_f32 v58, v58, v50
v_sub_f32 v59, v59, v50
v_mul_f32 v58, s40, v58
v_mul_f32 v59, s40, v59
v_exp_f32 v58, v58
v_exp_f32 v59, v59
v_add_f32 v51, v51, v58
v_add_f32 v52, v52, v59
v_lshlrev_b32 v58, 16, v87
v_and_b32 v59, 0xffff0000, v87
v_sub_f32 v58, v58, v50
v_sub_f32 v59, v59, v50
v_mul_f32 v58, s40, v58
v_mul_f32 v59, s40, v59
v_exp_f32 v58, v58
v_exp_f32 v59, v59
v_add_f32 v51, v51, v58
v_add_f32 v52, v52, v59
v_lshlrev_b32 v58, 16, v88
v_and_b32 v59, 0xffff0000, v88
v_sub_f32 v58, v58, v50
v_sub_f32 v59, v59, v50
v_mul_f32 v58, s40, v58
v_mul_f32 v59, s40, v59
v_exp_f32 v58, v58
v_exp_f32 v59, v59
v_add_f32 v51, v51, v58
v_add_f32 v52, v52, v59
v_lshlrev_b32 v58, 16, v89
v_and_b32 v59, 0xffff0000, v89
v_sub_f32 v58, v58, v50
v_sub_f32 v59, v59, v50
v_mul_f32 v58, s40, v58
v_mul_f32 v59, s40, v59
v_exp_f32 v58, v58
v_exp_f32 v59, v59
v_add_f32 v51, v51, v58
v_add_f32 v52, v52, v59
v_lshlrev_b32 v58, 16, v90
v_and_b32 v59, 0xffff0000, v90
v_sub_f32 v58, v58, v50
v_sub_f32 v59, v59, v50
v_mul_f32 v58, s40, v58
v_mul_f32 v59, s40, v59
v_exp_f32 v58, v58
v_exp_f32 v59, v59
v_add_f32 v51, v51, v58
v_add_f32 v52, v52, v59
v_lshlrev_b32 v58, 16, v91
v_and_b32 v59, 0xffff0000, v91
v_sub_f32 v58, v58, v50
v_sub_f32 v59, v59, v50
v_mul_f32 v58, s40, v58
v_mul_f32 v59, s40, v59
v_exp_f32 v58, v58
v_exp_f32 v59, v59
v_add_f32 v51, v51, v58
v_add_f32 v52, v52, v59
v_lshlrev_b32 v58, 16, v92
v_and_b32 v59, 0xffff0000, v92
v_sub_f32 v58, v58, v50
v_sub_f32 v59, v59, v50
v_mul_f32 v58, s40, v58
v_mul_f32 v59, s40, v59
v_exp_f32 v58, v58
v_exp_f32 v59, v59
v_add_f32 v51, v51, v58
v_add_f32 v52, v52, v59
v_lshlrev_b32 v58, 16, v93
v_and_b32 v59, 0xffff0000, v93
v_sub_f32 v58, v58, v50
v_sub_f32 v59, v59, v50
v_mul_f32 v58, s40, v58
v_mul_f32 v59, s40, v59
v_exp_f32 v58, v58
v_exp_f32 v59, v59
v_add_f32 v51, v51, v58
v_add_f32 v52, v52, v59
v_add_f32 v51, v51, v52
s_nop 1
v_add_f32_dpp v51, v51, v51 quad_perm:[1,0,3,2] row_mask:0xf bank_mask:0xf
s_nop 1
v_add_f32_dpp v51, v51, v51 quad_perm:[2,3,0,1] row_mask:0xf bank_mask:0xf
s_nop 1
v_add_f32_dpp v51, v51, v51 row_ror:4 row_mask:0xf bank_mask:0xf
s_nop 1
v_add_f32_dpp v51, v51, v51 row_ror:8 row_mask:0xf bank_mask:0xf
v_mov_b32 v58, v51
s_nop 1
v_permlane16_swap_b32 v51, v58
v_add_f32 v51, v51, v58
v_mov_b32 v58, v51
s_nop 1
v_permlane32_swap_b32 v51, v58
v_add_f32 v51, v51, v58
v_min_u32 v50, -2, v50
v_min_u32 v51, -2, v51
s_mov_b64 exec, 1
s_waitcnt vmcnt(0)
buffer_store_dwordx2 v[50:51], v1, s[36:39], s42 offen sc1
s_mov_b64 exec, -1
s_cmp_eq_u32 s94, 224
s_cbranch_scc1 L_f3
s_waitcnt vmcnt(0) lgkmcnt(0)
v_lshrrev_b32 v24, 16, v10
v_lshrrev_b32 v25, 16, v11
v_lshrrev_b32 v26, 16, v12
v_lshrrev_b32 v27, 16, v13
v_lshrrev_b32 v28, 16, v14
v_lshrrev_b32 v29, 16, v15
v_lshrrev_b32 v30, 16, v16
v_lshrrev_b32 v31, 16, v17
v_lshrrev_b32 v32, 16, v18
v_lshrrev_b32 v33, 16, v19
v_lshrrev_b32 v34, 16, v20
v_lshrrev_b32 v35, 16, v21
v_lshrrev_b32 v36, 16, v22
v_lshrrev_b32 v37, 16, v23
v_dot2_f32_bf16 v42, v176, v24, 0
v_dot2_f32_bf16 v43, v176, v10, 0
v_dot2_f32_bf16 v44, v177, v24, 0
v_dot2_f32_bf16 v45, v177, v10, 0
v_dot2_f32_bf16 v46, v178, v24, 0
v_dot2_f32_bf16 v47, v178, v10, 0
v_dot2_f32_bf16 v48, v179, v24, 0
v_dot2_f32_bf16 v49, v179, v10, 0
v_dot2_f32_bf16 v42, v180, v25, v42
v_dot2_f32_bf16 v43, v180, v11, v43
v_dot2_f32_bf16 v44, v181, v25, v44
v_dot2_f32_bf16 v45, v181, v11, v45
v_dot2_f32_bf16 v46, v182, v25, v46
v_dot2_f32_bf16 v47, v182, v11, v47
v_dot2_f32_bf16 v48, v183, v25, v48
v_dot2_f32_bf16 v49, v183, v11, v49
v_dot2_f32_bf16 v42, v184, v26, v42
v_dot2_f32_bf16 v43, v184, v12, v43
v_dot2_f32_bf16 v44, v185, v26, v44
v_dot2_f32_bf16 v45, v185, v12, v45
v_dot2_f32_bf16 v46, v186, v26, v46
v_dot2_f32_bf16 v47, v186, v12, v47
v_dot2_f32_bf16 v48, v187, v26, v48
v_dot2_f32_bf16 v49, v187, v12, v49
v_dot2_f32_bf16 v42, v188, v27, v42
v_dot2_f32_bf16 v43, v188, v13, v43
v_dot2_f32_bf16 v44, v189, v27, v44
v_dot2_f32_bf16 v45, v189, v13, v45
v_dot2_f32_bf16 v46, v190, v27, v46
v_dot2_f32_bf16 v47, v190, v13, v47
v_dot2_f32_bf16 v48, v191, v27, v48
v_dot2_f32_bf16 v49, v191, v13, v49
v_dot2_f32_bf16 v42, v192, v28, v42
v_dot2_f32_bf16 v43, v192, v14, v43
v_dot2_f32_bf16 v44, v193, v28, v44
v_dot2_f32_bf16 v45, v193, v14, v45
v_dot2_f32_bf16 v46, v194, v28, v46
v_dot2_f32_bf16 v47, v194, v14, v47
v_dot2_f32_bf16 v48, v195, v28, v48
v_dot2_f32_bf16 v49, v195, v14, v49
v_dot2_f32_bf16 v42, v196, v29, v42
v_dot2_f32_bf16 v43, v196, v15, v43
v_dot2_f32_bf16 v44, v197, v29, v44
v_dot2_f32_bf16 v45, v197, v15, v45
v_dot2_f32_bf16 v46, v198, v29, v46
v_dot2_f32_bf16 v47, v198, v15, v47
v_dot2_f32_bf16 v48, v199, v29, v48
v_dot2_f32_bf16 v49, v199, v15, v49
v_dot2_f32_bf16 v42, v200, v30, v42
v_dot2_f32_bf16 v43, v200, v16, v43
v_dot2_f32_bf16 v44, v201, v30, v44
v_dot2_f32_bf16 v45, v201, v16, v45
v_dot2_f32_bf16 v46, v202, v30, v46
v_dot2_f32_bf16 v47, v202, v16, v47
v_dot2_f32_bf16 v48, v203, v30, v48
v_dot2_f32_bf16 v49, v203, v16, v49
v_dot2_f32_bf16 v42, v204, v31, v42
v_dot2_f32_bf16 v43, v204, v17, v43
v_dot2_f32_bf16 v44, v205, v31, v44
v_dot2_f32_bf16 v45, v205, v17, v45
v_dot2_f32_bf16 v46, v206, v31, v46
v_dot2_f32_bf16 v47, v206, v17, v47
v_dot2_f32_bf16 v48, v207, v31, v48
v_dot2_f32_bf16 v49, v207, v17, v49
v_dot2_f32_bf16 v42, v208, v32, v42
v_dot2_f32_bf16 v43, v208, v18, v43
v_dot2_f32_bf16 v44, v209, v32, v44
v_dot2_f32_bf16 v45, v209, v18, v45
v_dot2_f32_bf16 v46, v210, v32, v46
v_dot2_f32_bf16 v47, v210, v18, v47
v_dot2_f32_bf16 v48, v211, v32, v48
v_dot2_f32_bf16 v49, v211, v18, v49
v_dot2_f32_bf16 v42, v212, v33, v42
v_dot2_f32_bf16 v43, v212, v19, v43
v_dot2_f32_bf16 v44, v213, v33, v44
v_dot2_f32_bf16 v45, v213, v19, v45
v_dot2_f32_bf16 v46, v214, v33, v46
v_dot2_f32_bf16 v47, v214, v19, v47
v_dot2_f32_bf16 v48, v215, v33, v48
v_dot2_f32_bf16 v49, v215, v19, v49
v_dot2_f32_bf16 v42, v216, v34, v42
v_dot2_f32_bf16 v43, v216, v20, v43
v_dot2_f32_bf16 v44, v217, v34, v44
v_dot2_f32_bf16 v45, v217, v20, v45
v_dot2_f32_bf16 v46, v218, v34, v46
v_dot2_f32_bf16 v47, v218, v20, v47
v_dot2_f32_bf16 v48, v219, v34, v48
v_dot2_f32_bf16 v49, v219, v20, v49
v_dot2_f32_bf16 v42, v220, v35, v42
v_dot2_f32_bf16 v43, v220, v21, v43
v_dot2_f32_bf16 v44, v221, v35, v44
v_dot2_f32_bf16 v45, v221, v21, v45
v_dot2_f32_bf16 v46, v222, v35, v46
v_dot2_f32_bf16 v47, v222, v21, v47
v_dot2_f32_bf16 v48, v223, v35, v48
v_dot2_f32_bf16 v49, v223, v21, v49
v_dot2_f32_bf16 v42, v224, v36, v42
v_dot2_f32_bf16 v43, v224, v22, v43
v_dot2_f32_bf16 v44, v225, v36, v44
v_dot2_f32_bf16 v45, v225, v22, v45
v_dot2_f32_bf16 v46, v226, v36, v46
v_dot2_f32_bf16 v47, v226, v22, v47
v_dot2_f32_bf16 v48, v227, v36, v48
v_dot2_f32_bf16 v49, v227, v22, v49
v_dot2_f32_bf16 v42, v228, v37, v42
v_dot2_f32_bf16 v43, v228, v23, v43
v_dot2_f32_bf16 v44, v229, v37, v44
v_dot2_f32_bf16 v45, v229, v23, v45
v_dot2_f32_bf16 v46, v230, v37, v46
v_dot2_f32_bf16 v47, v230, v23, v47
v_dot2_f32_bf16 v48, v231, v37, v48
v_dot2_f32_bf16 v49, v231, v23, v49
v_permlane32_swap_b32 v42, v46
s_nop 0
v_permlane32_swap_b32 v44, v48
v_add_f32 v42, v42, v46
v_add_f32 v44, v44, v48
s_nop 1
v_permlane16_swap_b32 v42, v44
v_add_f32 v42, v42, v44
v_permlane32_swap_b32 v43, v47
v_permlane32_swap_b32 v45, v49
v_add_f32 v43, v43, v47
v_add_f32 v45, v45, v49
s_nop 1
v_permlane16_swap_b32 v43, v45
v_add_f32 v43, v43, v45
v_add_f32_dpp v42, v42, v42 row_ror:8 row_mask:0xf bank_mask:0xf
s_nop 0
v_add_f32_dpp v43, v43, v43 row_ror:8 row_mask:0xf bank_mask:0xf
v_min_u32 v42, -2, v42
v_min_u32 v43, -2, v43
v_and_b32 v58, 7, v0
v_lshlrev_b32 v58, 5, v58
v_lshl_add_u32 v58, v7, 3, v58
s_mov_b32 exec_lo, 0xff00ff
s_mov_b32 exec_hi, 0xff00ff
buffer_store_dwordx2 v[42:43], v58, s[36:39], s95 offen sc1
s_mov_b64 exec, -1
L_f3:
v_lshlrev_b32 v59, 2, v0
s_mov_b32 s53, 0
L_apoll:
buffer_load_dword v58, v59, s[44:47], 0 offen sc1
s_waitcnt vmcnt(0)
v_cmp_eq_u32 vcc, 0, v58
s_and_b32 s43, vcc_lo, 0xffff
s_cbranch_scc1 L_help
s_bitcmp1_b32 s61, 0
s_cbranch_scc1 L_f4
v_and_b32 v58, 12, v0
v_add_u32 v58, v58, v7
v_cmp_gt_u32 s[88:89], 14, v58
s_mul_i32 s43, s93, 14
v_add_u32 v58, s43, v58
v_min_u32 v58, 0x6ff, v58
v_lshrrev_b32 v59, 6, v58
v_and_b32 v58, 63, v58
v_lshlrev_b32 v58, 2, v58
v_lshl_add_u32 v58, v59, 10, v58
v_and_b32 v59, 3, v0
v_lshl_add_u32 v58, v59, 8, v58
s_mov_b32 s43, 393216
s_mov_b32 s52, 421888
s_mov_b32 s53, 0
L_fpoll:
buffer_load_dword v42, v58, s[36:39], s43 offen sc1
buffer_load_dword v50, v58, s[36:39], s52 offen sc1
s_waitcnt vmcnt(0)
v_max_u32 v59, v42, v50
v_cmp_eq_u32 vcc, -1, v59
s_nop 0
s_cbranch_vccz L_fok
s_sleep 32
s_add_u32 s53, s53, 1
s_cmp_ge_u32 s53, 131072
s_cbranch_scc1 L_end
s_branch L_fpoll
L_fok:
v_add_f32_dpp v42, v42, v42 quad_perm:[1,0,3,2] row_mask:0xf bank_mask:0xf
v_add_f32_dpp v50, v50, v50 quad_perm:[1,0,3,2] row_mask:0xf bank_mask:0xf
s_nop 0
v_add_f32_dpp v42, v42, v42 quad_perm:[2,3,0,1] row_mask:0xf bank_mask:0xf
v_add_f32_dpp v50, v50, v50 quad_perm:[2,3,0,1] row_mask:0xf bank_mask:0xf
v_cvt_pk_bf16_f32 v58, v42, v50
v_lshlrev_b32 v42, 16, v58
v_and_b32 v50, 0xffff0000, v58
s_mov_b32 s48, 0x3d372713
v_mul_f32 v60, v42, v42
v_mul_f32 v60, v60, v42
v_fma_f32 v60, s48, v60, v42
v_mul_f32 v60, 0xc0135761, v60
v_exp_f32 v60, v60
s_nop 0
v_add_f32 v60, 1.0, v60
v_rcp_f32 v60, v60
s_nop 0
v_mul_f32 v42, v42, v60
v_cvt_pk_bf16_f32 v58, v42, v42
v_and_b32 v42, 0xffff0000, v58
v_mul_f32 v42, v42, v50
v_cvt_pk_bf16_f32 v42, v42, v42
v_cndmask_b32 v42, 0, v42, s[88:89]
s_nop 1
v_and_b32_dpp v78, v42, v38 row_newbcast:0 row_mask:0xf bank_mask:0xf
v_and_b32_dpp v79, v42, v39 row_newbcast:0 row_mask:0xf bank_mask:0xf
v_and_b32_dpp v80, v42, v40 row_newbcast:0 row_mask:0xf bank_mask:0xf
v_and_b32_dpp v81, v42, v41 row_newbcast:0 row_mask:0xf bank_mask:0xf
v_and_b32_dpp v82, v42, v38 row_newbcast:4 row_mask:0xf bank_mask:0xf
v_and_b32_dpp v83, v42, v39 row_newbcast:4 row_mask:0xf bank_mask:0xf
v_and_b32_dpp v84, v42, v40 row_newbcast:4 row_mask:0xf bank_mask:0xf
v_and_b32_dpp v85, v42, v41 row_newbcast:4 row_mask:0xf bank_mask:0xf
v_mfma_f32_16x16x32_bf16 v[94:97], v[112:115], v[78:81], v[94:97]
v_mfma_f32_16x16x32_bf16 v[98:101], v[116:119], v[78:81], v[98:101]
v_mfma_f32_16x16x32_bf16 v[102:105], v[120:123], v[78:81], v[102:105]
v_mfma_f32_16x16x32_bf16 v[106:109], v[124:127], v[78:81], v[106:109]
v_and_b32_dpp v86, v42, v38 row_newbcast:8 row_mask:0xf bank_mask:0xf
v_and_b32_dpp v87, v42, v39 row_newbcast:8 row_mask:0xf bank_mask:0xf
v_and_b32_dpp v88, v42, v40 row_newbcast:8 row_mask:0xf bank_mask:0xf
v_and_b32_dpp v89, v42, v41 row_newbcast:8 row_mask:0xf bank_mask:0xf
v_mfma_f32_16x16x32_bf16 v[94:97], v[128:131], v[82:85], v[94:97]
v_mfma_f32_16x16x32_bf16 v[98:101], v[132:135], v[82:85], v[98:101]
v_mfma_f32_16x16x32_bf16 v[102:105], v[136:139], v[82:85], v[102:105]
v_mfma_f32_16x16x32_bf16 v[106:109], v[140:143], v[82:85], v[106:109]
v_and_b32_dpp v90, v42, v38 row_newbcast:12 row_mask:0xf bank_mask:0xf
v_and_b32_dpp v91, v42, v39 row_newbcast:12 row_mask:0xf bank_mask:0xf
v_and_b32_dpp v92, v42, v40 row_newbcast:12 row_mask:0xf bank_mask:0xf
v_and_b32_dpp v93, v42, v41 row_newbcast:12 row_mask:0xf bank_mask:0xf
v_mfma_f32_16x16x32_bf16 v[94:97], v[144:147], v[86:89], v[94:97]
v_mfma_f32_16x16x32_bf16 v[98:101], v[148:151], v[86:89], v[98:101]
v_mfma_f32_16x16x32_bf16 v[102:105], v[152:155], v[86:89], v[102:105]
v_mfma_f32_16x16x32_bf16 v[106:109], v[156:159], v[86:89], v[106:109]
v_mfma_f32_16x16x32_bf16 v[94:97], v[160:163], v[90:93], v[94:97]
v_mfma_f32_16x16x32_bf16 v[98:101], v[164:167], v[90:93], v[98:101]
v_mfma_f32_16x16x32_bf16 v[102:105], v[168:171], v[90:93], v[102:105]
v_mfma_f32_16x16x32_bf16 v[106:109], v[172:175], v[90:93], v[106:109]
L_f4:
s_lshr_b32 s43, s57, 1
s_lshl_b32 s43, s43, 6
s_and_b32 s52, s57, 1
s_lshl_b32 s52, s52, 3
s_add_u32 s43, s43, s52
v_and_b32 v4, 3, v0
v_lshlrev_b32 v9, 1, v4
v_lshl_add_u32 v9, v7, 4, v9
v_add_u32 v9, s43, v9
v_mov_b32 v110, 0
buffer_load_short_d16_hi v110, v9, s[28:31], 0 offen
s_mov_b32 s28, s22
s_mov_b32 s29, s23
s_mov_b32 s30, 900
s_mov_b32 s31, 0x00020000
s_mov_b32 s32, s12
s_mov_b32 s33, s13
s_mov_b32 s34, 3670016
s_mov_b32 s35, 0x00020000
v_mul_u32_u24 v8, 7168, v7
v_add_u32 v8, v8, v5
s_lshl_b32 s43, s60, 8
s_bfe_u32 s52, s61, 0x10001
s_lshl_b32 s52, s52, 7
s_add_u32 s43, s43, s52
s_lshr_b32 s52, s61, 2
s_lshl_b32 s52, s52, 5
s_add_u32 s43, s43, s52
s_mul_i32 s49, s43, 896
s_add_u32 s63, s49, 3584
v_lshlrev_b32 v4, 4, v4
v_bfe_u32 v6, v0, 2, 1
v_lshl_add_u32 v4, v6, 13, v4
v_lshl_add_u32 v4, v7, 14, v4
v_bfe_u32 v6, v0, 3, 1
v_lshl_add_u32 v4, v6, 16, v4
v_and_b32 v6, 7, v0
v_lshlrev_b32 v6, 4, v6
v_lshrrev_b32 v5, 3, v0
v_lshl_add_u32 v6, v5, 11, v6
s_lshl_b32 s43, s60, 14
s_add_u32 s43, s43, 65536
s_lshl_b32 s52, s61, 7
s_add_u32 s59, s43, s52
s_lshl_b32 s43, s93, 6
s_add_u32 s55, s43, 524288
s_add_u32 s48, s55, 131072
s_mov_b32 s53, 0
v_and_b32 v59, 0, v0
v_lshlrev_b32 v59, 2, v59
L_wkick:
ds_read_b32 v58, v59 offset:672
s_waitcnt lgkmcnt(0)
v_cmp_eq_u32 vcc, -1, v58
s_nop 0
s_cbranch_vccz L_wkick_ok
s_sleep 4
s_add_u32 s53, s53, 1
s_cmp_ge_u32 s53, 1048576
s_cbranch_scc1 L_end
s_branch L_wkick
L_wkick_ok:
v_and_b32 v60, 15, v0
v_lshlrev_b32 v60, 7, v60
s_lshl_b32 s42, s60, 11
s_add_u32 s42, s42, 819200
s_mov_b32 s53, 0
L_cpoll:
buffer_load_dwordx2 v[42:43], v60, s[36:39], s42 offen sc1
s_waitcnt vmcnt(0)
v_max_u32 v58, v42, v43
v_cmp_eq_u32 vcc, -1, v58
s_nop 0
s_cbranch_vccz L_cok
s_sleep 16
s_add_u32 s53, s53, 1
s_cmp_ge_u32 s53, 131072
s_cbranch_scc1 L_end
s_branch L_cpoll
L_cok:
s_mov_b64 exec, 1
v_mov_b32 v2, 1
buffer_atomic_add v2, v1, s[36:39], s54 offen sc0
s_mov_b64 exec, -1
v_max_f32_dpp v58, v42, v42 row_ror:8 row_mask:0xf bank_mask:0xf
s_nop 1
v_max_f32_dpp v58, v58, v58 row_ror:4 row_mask:0xf bank_mask:0xf
s_nop 1
v_max_f32_dpp v58, v58, v58 row_ror:2 row_mask:0xf bank_mask:0xf
s_nop 1
v_max_f32_dpp v58, v58, v58 row_ror:1 row_mask:0xf bank_mask:0xf
v_sub_f32 v42, v42, v58
v_mul_f32 v42, s40, v42
v_exp_f32 v42, v42
s_nop 0
v_mul_f32 v111, v42, v43
s_nop 1
v_add_f32_dpp v111, v111, v111 row_ror:8 row_mask:0xf bank_mask:0xf
s_nop 1
v_add_f32_dpp v111, v111, v111 row_ror:4 row_mask:0xf bank_mask:0xf
s_nop 1
v_add_f32_dpp v111, v111, v111 row_ror:2 row_mask:0xf bank_mask:0xf
s_nop 1
v_add_f32_dpp v111, v111, v111 row_ror:1 row_mask:0xf bank_mask:0xf
v_rcp_f32 v111, v111
s_mov_b64 exec, 1
ds_write_b32 v1, v58 offset:520
s_mov_b32 s52, 0
L_tloop:
s_waitcnt vmcnt(0)
ds_write_b32 v1, v2 offset:512
v_readfirstlane_b32 s43, v2
s_add_u32 s52, s52, 1
s_cmp_gt_u32 s52, 1100
s_cselect_b32 s43, 128, s43
s_waitcnt lgkmcnt(0)
s_cmp_ge_u32 s43, 128
s_cbranch_scc1 L_tdone
v_mov_b32 v2, 1
buffer_atomic_add v2, v1, s[36:39], s54 offen sc0
s_barrier
s_waitcnt vmcnt(0)
ds_write_b32 v1, v2 offset:516
v_readfirstlane_b32 s43, v2
s_add_u32 s52, s52, 1
s_cmp_gt_u32 s52, 1100
s_cselect_b32 s43, 128, s43
s_waitcnt lgkmcnt(0)
s_cmp_ge_u32 s43, 128
s_cbranch_scc1 L_tdone
v_mov_b32 v2, 1
buffer_atomic_add v2, v1, s[36:39], s54 offen sc0
s_barrier
s_branch L_tloop
L_tdone:
s_barrier
s_mov_b64 exec, -1
s_bitcmp1_b32 s61, 0
s_cbranch_scc1 L_wo
buffer_load_dwordx4 v[112:115], v8, s[32:35], s49 offen offset:0 nt
buffer_load_dwordx4 v[128:131], v8, s[32:35], s49 offen offset:896 nt
buffer_load_dwordx4 v[144:147], v8, s[32:35], s49 offen offset:1792 nt
buffer_load_dwordx4 v[160:163], v8, s[32:35], s49 offen offset:2688 nt
buffer_load_dwordx4 v[116:119], v8, s[32:35], s49 offen offset:256 nt
buffer_load_dwordx4 v[132:135], v8, s[32:35], s49 offen offset:1152 nt
buffer_load_dwordx4 v[148:151], v8, s[32:35], s49 offen offset:2048 nt
buffer_load_dwordx4 v[164:167], v8, s[32:35], s49 offen offset:2944 nt
buffer_load_dwordx4 v[120:123], v8, s[32:35], s49 offen offset:512 nt
buffer_load_dwordx4 v[136:139], v8, s[32:35], s49 offen offset:1408 nt
buffer_load_dwordx4 v[152:155], v8, s[32:35], s49 offen offset:2304 nt
buffer_load_dwordx4 v[168:171], v8, s[32:35], s49 offen offset:3200 nt
s_mov_b32 exec_lo, 0xff00ff
s_mov_b32 exec_hi, 0xff00ff
buffer_load_dwordx4 v[124:127], v8, s[32:35], s49 offen offset:768 nt
buffer_load_dwordx4 v[140:143], v8, s[32:35], s49 offen offset:1664 nt
buffer_load_dwordx4 v[156:159], v8, s[32:35], s49 offen offset:2560 nt
buffer_load_dwordx4 v[172:175], v8, s[32:35], s49 offen offset:3456 nt
s_mov_b64 exec, -1
buffer_load_dwordx4 v[176:179], v8, s[32:35], s63 offen offset:0 nt
buffer_load_dwordx4 v[192:195], v8, s[32:35], s63 offen offset:896 nt
buffer_load_dwordx4 v[208:211], v8, s[32:35], s63 offen offset:1792 nt
buffer_load_dwordx4 v[224:227], v8, s[32:35], s63 offen offset:2688 nt
buffer_load_dwordx4 v[180:183], v8, s[32:35], s63 offen offset:256 nt
buffer_load_dwordx4 v[196:199], v8, s[32:35], s63 offen offset:1152 nt
buffer_load_dwordx4 v[212:215], v8, s[32:35], s63 offen offset:2048 nt
buffer_load_dwordx4 v[228:231], v8, s[32:35], s63 offen offset:2944 nt
buffer_load_dwordx4 v[184:187], v8, s[32:35], s63 offen offset:512 nt
buffer_load_dwordx4 v[200:203], v8, s[32:35], s63 offen offset:1408 nt
buffer_load_dwordx4 v[216:219], v8, s[32:35], s63 offen offset:2304 nt
buffer_load_dwordx4 v[232:235], v8, s[32:35], s63 offen offset:3200 nt
s_mov_b32 exec_lo, 0xff00ff
s_mov_b32 exec_hi, 0xff00ff
buffer_load_dwordx4 v[188:191], v8, s[32:35], s63 offen offset:768 nt
buffer_load_dwordx4 v[204:207], v8, s[32:35], s63 offen offset:1664 nt
buffer_load_dwordx4 v[220:223], v8, s[32:35], s63 offen offset:2560 nt
buffer_load_dwordx4 v[236:239], v8, s[32:35], s63 offen offset:3456 nt
s_mov_b64 exec, -1
L_wo:
s_barrier
ds_read_b128 v[42:45], v3 offset:1024
ds_read_b128 v[46:49], v3 offset:2048
ds_read_b128 v[50:53], v3 offset:3072
ds_read_b128 v[54:57], v3 offset:4096
s_waitcnt lgkmcnt(2)
v_pk_add_f32 v[42:43], v[42:43], v[46:47]
v_pk_add_f32 v[44:45], v[44:45], v[48:49]
s_waitcnt lgkmcnt(0)
v_pk_add_f32 v[50:51], v[50:51], v[54:55]
v_pk_add_f32 v[52:53], v[52:53], v[56:57]
v_pk_add_f32 v[42:43], v[42:43], v[50:51]
v_pk_add_f32 v[44:45], v[44:45], v[52:53]
v_mul_f32 v42, v42, v111
v_mul_f32 v43, v43, v111
v_mul_f32 v44, v44, v111
v_mul_f32 v45, v45, v111
v_min_u32 v42, -2, v42
v_min_u32 v43, -2, v43
v_min_u32 v44, -2, v44
v_min_u32 v45, -2, v45
buffer_store_dwordx4 v[42:45], v6, s[36:39], s59 offen sc1
s_mov_b32 s53, 0
s_bitcmp1_b32 s61, 0
s_cbranch_scc1 L_upper
buffer_load_dwordx4 v[50:53], v3, s[36:39], s58 offen offset:0 sc1
buffer_load_dwordx4 v[54:57], v3, s[36:39], s58 offen offset:1024 sc1
L_poll1:
s_add_u32 s53, s53, 1
s_cmp_ge_u32 s53, 131072
s_cbranch_scc1 L_end
buffer_load_dwordx4 v[10:13], v3, s[36:39], s58 offen offset:0 sc1
buffer_load_dwordx4 v[14:17], v3, s[36:39], s58 offen offset:1024 sc1
s_waitcnt vmcnt(2)
v_max3_u32 v58, v50, v51, v52
v_max3_u32 v58, v58, v53, v54
v_max3_u32 v58, v58, v55, v56
v_max_u32 v58, v58, v57
v_cmp_eq_u32 vcc, -1, v58
s_nop 0
s_cbranch_vccz L_poll1_0
buffer_load_dwordx4 v[50:53], v3, s[36:39], s58 offen offset:0 sc1
buffer_load_dwordx4 v[54:57], v3, s[36:39], s58 offen offset:1024 sc1
s_waitcnt vmcnt(2)
v_max3_u32 v58, v10, v11, v12
v_max3_u32 v58, v58, v13, v14
v_max3_u32 v58, v58, v15, v16
v_max_u32 v58, v58, v17
v_cmp_eq_u32 vcc, -1, v58
s_nop 0
s_cbranch_vccnz L_poll1
v_pk_add_f32 v[42:43], v[10:11], v[14:15]
v_pk_add_f32 v[44:45], v[12:13], v[16:17]
s_nop 0
s_branch L_poll1_done
L_poll1_0:
v_pk_add_f32 v[42:43], v[50:51], v[54:55]
v_pk_add_f32 v[44:45], v[52:53], v[56:57]
L_poll1_done:
s_nop 1
v_permlane32_swap_b32 v42, v44
v_permlane32_swap_b32 v43, v45
v_add_f32 v42, v42, v44
v_add_f32 v43, v43, v45
s_nop 1
v_permlane16_swap_b32 v42, v43
v_add_f32 v42, v42, v43
s_nop 1
v_add_f32_dpp v42, v42, v42 row_ror:8 row_mask:0xf bank_mask:0xf
v_cvt_pk_bf16_f32 v42, v42, v42
s_nop 1
v_and_b32_dpp v78, v42, v38 row_newbcast:0 row_mask:0xf bank_mask:0xf
v_and_b32_dpp v79, v42, v39 row_newbcast:0 row_mask:0xf bank_mask:0xf
v_and_b32_dpp v80, v42, v40 row_newbcast:0 row_mask:0xf bank_mask:0xf
v_and_b32_dpp v81, v42, v41 row_newbcast:0 row_mask:0xf bank_mask:0xf
v_and_b32_dpp v82, v42, v38 row_newbcast:1 row_mask:0xf bank_mask:0xf
v_and_b32_dpp v83, v42, v39 row_newbcast:1 row_mask:0xf bank_mask:0xf
v_and_b32_dpp v84, v42, v40 row_newbcast:1 row_mask:0xf bank_mask:0xf
v_and_b32_dpp v85, v42, v41 row_newbcast:1 row_mask:0xf bank_mask:0xf
v_mfma_f32_16x16x32_bf16 v[94:97], v[112:115], v[78:81], v[94:97]
v_mfma_f32_16x16x32_bf16 v[98:101], v[116:119], v[78:81], v[98:101]
v_and_b32_dpp v86, v42, v38 row_newbcast:2 row_mask:0xf bank_mask:0xf
v_and_b32_dpp v87, v42, v39 row_newbcast:2 row_mask:0xf bank_mask:0xf
v_and_b32_dpp v88, v42, v40 row_newbcast:2 row_mask:0xf bank_mask:0xf
v_and_b32_dpp v89, v42, v41 row_newbcast:2 row_mask:0xf bank_mask:0xf
v_mfma_f32_16x16x32_bf16 v[94:97], v[128:131], v[82:85], v[94:97]
v_mfma_f32_16x16x32_bf16 v[98:101], v[132:135], v[82:85], v[98:101]
v_and_b32_dpp v90, v42, v38 row_newbcast:3 row_mask:0xf bank_mask:0xf
v_and_b32_dpp v91, v42, v39 row_newbcast:3 row_mask:0xf bank_mask:0xf
v_and_b32_dpp v92, v42, v40 row_newbcast:3 row_mask:0xf bank_mask:0xf
v_and_b32_dpp v93, v42, v41 row_newbcast:3 row_mask:0xf bank_mask:0xf
v_mfma_f32_16x16x32_bf16 v[94:97], v[144:147], v[86:89], v[94:97]
v_mfma_f32_16x16x32_bf16 v[98:101], v[148:151], v[86:89], v[98:101]
v_and_b32_dpp v240, v42, v38 row_newbcast:4 row_mask:0xf bank_mask:0xf
v_and_b32_dpp v241, v42, v39 row_newbcast:4 row_mask:0xf bank_mask:0xf
v_and_b32_dpp v242, v42, v40 row_newbcast:4 row_mask:0xf bank_mask:0xf
v_and_b32_dpp v243, v42, v41 row_newbcast:4 row_mask:0xf bank_mask:0xf
v_mfma_f32_16x16x32_bf16 v[94:97], v[160:163], v[90:93], v[94:97]
v_mfma_f32_16x16x32_bf16 v[98:101], v[164:167], v[90:93], v[98:101]
v_and_b32_dpp v244, v42, v38 row_newbcast:5 row_mask:0xf bank_mask:0xf
v_and_b32_dpp v245, v42, v39 row_newbcast:5 row_mask:0xf bank_mask:0xf
v_and_b32_dpp v246, v42, v40 row_newbcast:5 row_mask:0xf bank_mask:0xf
v_and_b32_dpp v247, v42, v41 row_newbcast:5 row_mask:0xf bank_mask:0xf
v_mfma_f32_16x16x32_bf16 v[94:97], v[176:179], v[240:243], v[94:97]
v_mfma_f32_16x16x32_bf16 v[98:101], v[180:183], v[240:243], v[98:101]
v_and_b32_dpp v248, v42, v38 row_newbcast:6 row_mask:0xf bank_mask:0xf
v_and_b32_dpp v249, v42, v39 row_newbcast:6 row_mask:0xf bank_mask:0xf
v_and_b32_dpp v250, v42, v40 row_newbcast:6 row_mask:0xf bank_mask:0xf
v_and_b32_dpp v251, v42, v41 row_newbcast:6 row_mask:0xf bank_mask:0xf
v_mfma_f32_16x16x32_bf16 v[94:97], v[192:195], v[244:247], v[94:97]
v_mfma_f32_16x16x32_bf16 v[98:101], v[196:199], v[244:247], v[98:101]
v_and_b32_dpp v252, v42, v38 row_newbcast:7 row_mask:0xf bank_mask:0xf
v_and_b32_dpp v253, v42, v39 row_newbcast:7 row_mask:0xf bank_mask:0xf
v_and_b32_dpp v254, v42, v40 row_newbcast:7 row_mask:0xf bank_mask:0xf
v_and_b32_dpp v255, v42, v41 row_newbcast:7 row_mask:0xf bank_mask:0xf
v_mfma_f32_16x16x32_bf16 v[94:97], v[208:211], v[248:251], v[94:97]
v_mfma_f32_16x16x32_bf16 v[98:101], v[212:215], v[248:251], v[98:101]
v_mfma_f32_16x16x32_bf16 v[94:97], v[224:227], v[252:255], v[94:97]
v_mfma_f32_16x16x32_bf16 v[98:101], v[228:231], v[252:255], v[98:101]
v_mfma_f32_16x16x32_bf16 v[102:105], v[120:123], v[78:81], v[102:105]
v_mfma_f32_16x16x32_bf16 v[106:109], v[124:127], v[78:81], v[106:109]
v_mfma_f32_16x16x32_bf16 v[102:105], v[136:139], v[82:85], v[102:105]
v_mfma_f32_16x16x32_bf16 v[106:109], v[140:143], v[82:85], v[106:109]
v_mfma_f32_16x16x32_bf16 v[102:105], v[152:155], v[86:89], v[102:105]
v_mfma_f32_16x16x32_bf16 v[106:109], v[156:159], v[86:89], v[106:109]
v_mfma_f32_16x16x32_bf16 v[102:105], v[168:171], v[90:93], v[102:105]
v_mfma_f32_16x16x32_bf16 v[106:109], v[172:175], v[90:93], v[106:109]
v_cndmask_b32 v94, v94, v98, s[50:51]
v_cndmask_b32 v95, v95, v99, s[50:51]
v_cndmask_b32 v96, v96, v100, s[50:51]
v_cndmask_b32 v97, v97, v101, s[50:51]
v_min_u32 v94, -2, v94
v_min_u32 v95, -2, v95
v_min_u32 v96, -2, v96
v_min_u32 v97, -2, v97
buffer_store_dwordx4 v[94:97], v4, s[36:39], s55 offen sc1
v_mfma_f32_16x16x32_bf16 v[102:105], v[184:187], v[240:243], v[102:105]
v_mfma_f32_16x16x32_bf16 v[106:109], v[188:191], v[240:243], v[106:109]
v_mfma_f32_16x16x32_bf16 v[102:105], v[200:203], v[244:247], v[102:105]
v_mfma_f32_16x16x32_bf16 v[106:109], v[204:207], v[244:247], v[106:109]
v_mfma_f32_16x16x32_bf16 v[102:105], v[216:219], v[248:251], v[102:105]
v_mfma_f32_16x16x32_bf16 v[106:109], v[220:223], v[248:251], v[106:109]
v_mfma_f32_16x16x32_bf16 v[102:105], v[232:235], v[252:255], v[102:105]
v_mfma_f32_16x16x32_bf16 v[106:109], v[236:239], v[252:255], v[106:109]
s_nop 7
v_cndmask_b32 v102, v102, v106, s[50:51]
v_cndmask_b32 v103, v103, v107, s[50:51]
v_cndmask_b32 v104, v104, v108, s[50:51]
v_cndmask_b32 v105, v105, v109, s[50:51]
v_min_u32 v102, -2, v102
v_min_u32 v103, -2, v103
v_min_u32 v104, -2, v104
v_min_u32 v105, -2, v105
s_mov_b32 exec_hi, 0x00ff00ff
buffer_store_dwordx4 v[102:105], v4, s[36:39], s48 offen sc1
s_nop 0
s_branch L_hend
L_upper:
s_cmp_lg_u32 s41, 2
s_cbranch_scc1 L_hend
buffer_load_dwordx4 v[112:115], v3, s[36:39], s56 offen offset:0 sc1
buffer_load_dwordx4 v[116:119], v3, s[36:39], s56 offen offset:1024 sc1
buffer_load_dwordx4 v[120:123], v3, s[36:39], s56 offen offset:2048 sc1
buffer_load_dwordx4 v[124:127], v3, s[36:39], s56 offen offset:3072 sc1
buffer_load_dwordx4 v[128:131], v3, s[36:39], s92 offen offset:0 sc1
buffer_load_dwordx4 v[132:135], v3, s[36:39], s92 offen offset:1024 sc1
buffer_load_dwordx4 v[136:139], v3, s[36:39], s92 offen offset:2048 sc1
buffer_load_dwordx4 v[140:143], v3, s[36:39], s92 offen offset:3072 sc1
L_poll2:
s_add_u32 s53, s53, 1
s_cmp_ge_u32 s53, 131072
s_cbranch_scc1 L_end
buffer_load_dwordx4 v[144:147], v3, s[36:39], s56 offen offset:0 sc1
buffer_load_dwordx4 v[148:151], v3, s[36:39], s56 offen offset:1024 sc1
buffer_load_dwordx4 v[152:155], v3, s[36:39], s56 offen offset:2048 sc1
buffer_load_dwordx4 v[156:159], v3, s[36:39], s56 offen offset:3072 sc1
buffer_load_dwordx4 v[160:163], v3, s[36:39], s92 offen offset:0 sc1
buffer_load_dwordx4 v[164:167], v3, s[36:39], s92 offen offset:1024 sc1
buffer_load_dwordx4 v[168:171], v3, s[36:39], s92 offen offset:2048 sc1
buffer_load_dwordx4 v[172:175], v3, s[36:39], s92 offen offset:3072 sc1
s_waitcnt vmcnt(12)
v_max3_u32 v58, v112, v113, v114
v_max3_u32 v58, v58, v115, v116
v_max3_u32 v58, v58, v117, v118
v_max3_u32 v58, v58, v119, v120
v_max3_u32 v58, v58, v121, v122
v_max3_u32 v58, v58, v123, v124
v_max3_u32 v58, v58, v125, v126
v_max_u32 v58, v58, v127
v_cmp_eq_u32 vcc, -1, v58
s_waitcnt vmcnt(8)
v_max3_u32 v58, v58, v128, v129
v_max3_u32 v58, v58, v130, v131
v_max3_u32 v58, v58, v132, v133
v_max3_u32 v58, v58, v134, v135
v_max3_u32 v58, v58, v136, v137
v_max3_u32 v58, v58, v138, v139
v_max3_u32 v58, v58, v140, v141
v_max3_u32 v58, v58, v142, v143
v_cmp_eq_u32 vcc, -1, v58
s_nop 0
s_cbranch_vccz L_poll2_0
buffer_load_dwordx4 v[112:115], v3, s[36:39], s56 offen offset:0 sc1
buffer_load_dwordx4 v[116:119], v3, s[36:39], s56 offen offset:1024 sc1
buffer_load_dwordx4 v[120:123], v3, s[36:39], s56 offen offset:2048 sc1
buffer_load_dwordx4 v[124:127], v3, s[36:39], s56 offen offset:3072 sc1
buffer_load_dwordx4 v[128:131], v3, s[36:39], s92 offen offset:0 sc1
buffer_load_dwordx4 v[132:135], v3, s[36:39], s92 offen offset:1024 sc1
buffer_load_dwordx4 v[136:139], v3, s[36:39], s92 offen offset:2048 sc1
buffer_load_dwordx4 v[140:143], v3, s[36:39], s92 offen offset:3072 sc1
s_waitcnt vmcnt(12)
v_max3_u32 v58, v144, v145, v146
v_max3_u32 v58, v58, v147, v148
v_max3_u32 v58, v58, v149, v150
v_max3_u32 v58, v58, v151, v152
v_max3_u32 v58, v58, v153, v154
v_max3_u32 v58, v58, v155, v156
v_max3_u32 v58, v58, v157, v158
v_max_u32 v58, v58, v159
v_cmp_eq_u32 vcc, -1, v58
s_waitcnt vmcnt(8)
v_max3_u32 v58, v58, v160, v161
v_max3_u32 v58, v58, v162, v163
v_max3_u32 v58, v58, v164, v165
v_max3_u32 v58, v58, v166, v167
v_max3_u32 v58, v58, v168, v169
v_max3_u32 v58, v58, v170, v171
v_max3_u32 v58, v58, v172, v173
v_max3_u32 v58, v58, v174, v175
v_cmp_eq_u32 vcc, -1, v58
s_nop 0
s_cbranch_vccnz L_poll2
v_pk_add_f32 v[42:43], v[144:145], v[160:161]
v_pk_add_f32 v[44:45], v[146:147], v[162:163]
v_pk_add_f32 v[46:47], v[148:149], v[164:165]
v_pk_add_f32 v[48:49], v[150:151], v[166:167]
v_pk_add_f32 v[50:51], v[152:153], v[168:169]
v_pk_add_f32 v[52:53], v[154:155], v[170:171]
v_pk_add_f32 v[54:55], v[156:157], v[172:173]
v_pk_add_f32 v[56:57], v[158:159], v[174:175]
s_nop 0
s_branch L_poll2_done
L_poll2_0:
v_pk_add_f32 v[42:43], v[112:113], v[128:129]
v_pk_add_f32 v[44:45], v[114:115], v[130:131]
v_pk_add_f32 v[46:47], v[116:117], v[132:133]
v_pk_add_f32 v[48:49], v[118:119], v[134:135]
v_pk_add_f32 v[50:51], v[120:121], v[136:137]
v_pk_add_f32 v[52:53], v[122:123], v[138:139]
v_pk_add_f32 v[54:55], v[124:125], v[140:141]
v_pk_add_f32 v[56:57], v[126:127], v[142:143]
L_poll2_done:
v_pk_add_f32 v[42:43], v[42:43], v[50:51]
v_pk_add_f32 v[44:45], v[44:45], v[52:53]
v_pk_add_f32 v[46:47], v[46:47], v[54:55]
v_pk_add_f32 v[48:49], v[48:49], v[56:57]
v_pk_add_f32 v[42:43], v[42:43], v[46:47]
v_pk_add_f32 v[44:45], v[44:45], v[48:49]
s_nop 1
v_permlane32_swap_b32 v42, v44
v_permlane32_swap_b32 v43, v45
v_add_f32 v42, v42, v44
v_add_f32 v43, v43, v45
s_nop 1
v_permlane16_swap_b32 v42, v43
v_add_f32 v42, v42, v43
s_nop 1
v_add_f32_dpp v42, v42, v42 row_ror:4 row_mask:0xf bank_mask:0xf
s_nop 1
v_add_f32_dpp v42, v42, v42 row_ror:8 row_mask:0xf bank_mask:0xf
v_add_f32 v42, v110, v42
v_cvt_pk_bf16_f32 v42, v42, v42
s_mov_b32 exec_lo, 0xf000f
s_mov_b32 exec_hi, 0xf000f
buffer_store_short v42, v9, s[28:31], 0 offen
L_hend:
L_end:
s_endpgm
L_qself:
s_lshl_b32 s52, s60, 9
v_lshrrev_b32 v66, 1, v4
s_mov_b32 s53, 0
L_qs:
s_mov_b32 s43, s52
buffer_load_dwordx4 v[112:115], v2, s[32:35], s43 offen
s_add_u32 s43, s43, 262144
buffer_load_dwordx4 v[116:119], v2, s[32:35], s43 offen
s_add_u32 s43, s43, 262144
buffer_load_dwordx4 v[120:123], v2, s[32:35], s43 offen
s_add_u32 s43, s43, 262144
buffer_load_dwordx4 v[124:127], v2, s[32:35], s43 offen
s_add_u32 s43, s43, 262144
buffer_load_dwordx4 v[128:131], v2, s[32:35], s43 offen
s_add_u32 s43, s43, 262144
buffer_load_dwordx4 v[132:135], v2, s[32:35], s43 offen
s_add_u32 s43, s43, 262144
buffer_load_dwordx4 v[136:139], v2, s[32:35], s43 offen
s_add_u32 s43, s43, 262144
buffer_load_dwordx4 v[140:143], v2, s[32:35], s43 offen
s_add_u32 s43, s43, 262144
buffer_load_dwordx4 v[144:147], v2, s[32:35], s43 offen
s_add_u32 s43, s43, 262144
buffer_load_dwordx4 v[148:151], v2, s[32:35], s43 offen
s_add_u32 s43, s43, 262144
buffer_load_dwordx4 v[152:155], v2, s[32:35], s43 offen
s_add_u32 s43, s43, 262144
buffer_load_dwordx4 v[156:159], v2, s[32:35], s43 offen
s_add_u32 s43, s43, 262144
buffer_load_dwordx4 v[160:163], v2, s[32:35], s43 offen
s_add_u32 s43, s43, 262144
buffer_load_dwordx4 v[164:167], v2, s[32:35], s43 offen
s_waitcnt vmcnt(0)
v_dot2_f32_bf16 v42, v112, v24, 0
v_dot2_f32_bf16 v43, v112, v10, 0
v_dot2_f32_bf16 v44, v113, v24, 0
v_dot2_f32_bf16 v45, v113, v10, 0
v_dot2_f32_bf16 v46, v114, v24, 0
v_dot2_f32_bf16 v47, v114, v10, 0
v_dot2_f32_bf16 v48, v115, v24, 0
v_dot2_f32_bf16 v49, v115, v10, 0
v_dot2_f32_bf16 v42, v116, v25, v42
v_dot2_f32_bf16 v43, v116, v11, v43
v_dot2_f32_bf16 v44, v117, v25, v44
v_dot2_f32_bf16 v45, v117, v11, v45
v_dot2_f32_bf16 v46, v118, v25, v46
v_dot2_f32_bf16 v47, v118, v11, v47
v_dot2_f32_bf16 v48, v119, v25, v48
v_dot2_f32_bf16 v49, v119, v11, v49
v_dot2_f32_bf16 v42, v120, v26, v42
v_dot2_f32_bf16 v43, v120, v12, v43
v_dot2_f32_bf16 v44, v121, v26, v44
v_dot2_f32_bf16 v45, v121, v12, v45
v_dot2_f32_bf16 v46, v122, v26, v46
v_dot2_f32_bf16 v47, v122, v12, v47
v_dot2_f32_bf16 v48, v123, v26, v48
v_dot2_f32_bf16 v49, v123, v12, v49
v_dot2_f32_bf16 v42, v124, v27, v42
v_dot2_f32_bf16 v43, v124, v13, v43
v_dot2_f32_bf16 v44, v125, v27, v44
v_dot2_f32_bf16 v45, v125, v13, v45
v_dot2_f32_bf16 v46, v126, v27, v46
v_dot2_f32_bf16 v47, v126, v13, v47
v_dot2_f32_bf16 v48, v127, v27, v48
v_dot2_f32_bf16 v49, v127, v13, v49
v_dot2_f32_bf16 v42, v128, v28, v42
v_dot2_f32_bf16 v43, v128, v14, v43
v_dot2_f32_bf16 v44, v129, v28, v44
v_dot2_f32_bf16 v45, v129, v14, v45
v_dot2_f32_bf16 v46, v130, v28, v46
v_dot2_f32_bf16 v47, v130, v14, v47
v_dot2_f32_bf16 v48, v131, v28, v48
v_dot2_f32_bf16 v49, v131, v14, v49
v_dot2_f32_bf16 v42, v132, v29, v42
v_dot2_f32_bf16 v43, v132, v15, v43
v_dot2_f32_bf16 v44, v133, v29, v44
v_dot2_f32_bf16 v45, v133, v15, v45
v_dot2_f32_bf16 v46, v134, v29, v46
v_dot2_f32_bf16 v47, v134, v15, v47
v_dot2_f32_bf16 v48, v135, v29, v48
v_dot2_f32_bf16 v49, v135, v15, v49
v_dot2_f32_bf16 v42, v136, v30, v42
v_dot2_f32_bf16 v43, v136, v16, v43
v_dot2_f32_bf16 v44, v137, v30, v44
v_dot2_f32_bf16 v45, v137, v16, v45
v_dot2_f32_bf16 v46, v138, v30, v46
v_dot2_f32_bf16 v47, v138, v16, v47
v_dot2_f32_bf16 v48, v139, v30, v48
v_dot2_f32_bf16 v49, v139, v16, v49
v_dot2_f32_bf16 v42, v140, v31, v42
v_dot2_f32_bf16 v43, v140, v17, v43
v_dot2_f32_bf16 v44, v141, v31, v44
v_dot2_f32_bf16 v45, v141, v17, v45
v_dot2_f32_bf16 v46, v142, v31, v46
v_dot2_f32_bf16 v47, v142, v17, v47
v_dot2_f32_bf16 v48, v143, v31, v48
v_dot2_f32_bf16 v49, v143, v17, v49
v_dot2_f32_bf16 v42, v144, v32, v42
v_dot2_f32_bf16 v43, v144, v18, v43
v_dot2_f32_bf16 v44, v145, v32, v44
v_dot2_f32_bf16 v45, v145, v18, v45
v_dot2_f32_bf16 v46, v146, v32, v46
v_dot2_f32_bf16 v47, v146, v18, v47
v_dot2_f32_bf16 v48, v147, v32, v48
v_dot2_f32_bf16 v49, v147, v18, v49
v_dot2_f32_bf16 v42, v148, v33, v42
v_dot2_f32_bf16 v43, v148, v19, v43
v_dot2_f32_bf16 v44, v149, v33, v44
v_dot2_f32_bf16 v45, v149, v19, v45
v_dot2_f32_bf16 v46, v150, v33, v46
v_dot2_f32_bf16 v47, v150, v19, v47
v_dot2_f32_bf16 v48, v151, v33, v48
v_dot2_f32_bf16 v49, v151, v19, v49
v_dot2_f32_bf16 v42, v152, v34, v42
v_dot2_f32_bf16 v43, v152, v20, v43
v_dot2_f32_bf16 v44, v153, v34, v44
v_dot2_f32_bf16 v45, v153, v20, v45
v_dot2_f32_bf16 v46, v154, v34, v46
v_dot2_f32_bf16 v47, v154, v20, v47
v_dot2_f32_bf16 v48, v155, v34, v48
v_dot2_f32_bf16 v49, v155, v20, v49
v_dot2_f32_bf16 v42, v156, v35, v42
v_dot2_f32_bf16 v43, v156, v21, v43
v_dot2_f32_bf16 v44, v157, v35, v44
v_dot2_f32_bf16 v45, v157, v21, v45
v_dot2_f32_bf16 v46, v158, v35, v46
v_dot2_f32_bf16 v47, v158, v21, v47
v_dot2_f32_bf16 v48, v159, v35, v48
v_dot2_f32_bf16 v49, v159, v21, v49
v_dot2_f32_bf16 v42, v160, v36, v42
v_dot2_f32_bf16 v43, v160, v22, v43
v_dot2_f32_bf16 v44, v161, v36, v44
v_dot2_f32_bf16 v45, v161, v22, v45
v_dot2_f32_bf16 v46, v162, v36, v46
v_dot2_f32_bf16 v47, v162, v22, v47
v_dot2_f32_bf16 v48, v163, v36, v48
v_dot2_f32_bf16 v49, v163, v22, v49
v_dot2_f32_bf16 v42, v164, v37, v42
v_dot2_f32_bf16 v43, v164, v23, v43
v_dot2_f32_bf16 v44, v165, v37, v44
v_dot2_f32_bf16 v45, v165, v23, v45
v_dot2_f32_bf16 v46, v166, v37, v46
v_dot2_f32_bf16 v47, v166, v23, v47
v_dot2_f32_bf16 v48, v167, v37, v48
v_dot2_f32_bf16 v49, v167, v23, v49
v_permlane32_swap_b32 v42, v46
s_nop 0
v_permlane32_swap_b32 v44, v48
v_add_f32 v42, v42, v46
v_add_f32 v44, v44, v48
s_nop 1
v_permlane16_swap_b32 v42, v44
v_add_f32 v42, v42, v44
v_permlane32_swap_b32 v43, v47
v_permlane32_swap_b32 v45, v49
v_add_f32 v43, v43, v47
v_add_f32 v45, v45, v49
s_nop 1
v_permlane16_swap_b32 v43, v45
v_add_f32 v43, v43, v45
v_add_f32_dpp v42, v42, v42 quad_perm:[2,3,0,1] row_mask:0xf bank_mask:0xf
s_nop 0
v_add_f32_dpp v43, v43, v43 quad_perm:[2,3,0,1] row_mask:0xf bank_mask:0xf
v_add_f32_dpp v42, v42, v42 row_ror:4 row_mask:0xf bank_mask:0xf
s_nop 0
v_add_f32_dpp v43, v43, v43 row_ror:4 row_mask:0xf bank_mask:0xf
v_add_f32_dpp v42, v42, v42 row_ror:8 row_mask:0xf bank_mask:0xf
s_nop 0
v_add_f32_dpp v43, v43, v43 row_ror:8 row_mask:0xf bank_mask:0xf
v_cvt_pk_bf16_f32 v58, v42, v43
s_mov_b32 exec_lo, 0x30003
s_mov_b32 exec_hi, 0x30003
ds_write_b32 v66, v58
s_mov_b64 exec, -1
v_add_u32 v66, 32, v66
s_add_u32 s52, s52, 32
s_add_u32 s53, s53, 1
s_cmp_lt_u32 s53, 16
s_cbranch_scc1 L_qs
s_cmp_lg_u32 s61, 0
s_cbranch_scc1 L_qok
s_mov_b32 s87, 1
v_mov_b32 v58, 64
v_mov_b32 v59, 1
s_mov_b64 exec, 1
buffer_store_dword v59, v58, s[44:47], 0 offen sc1
s_mov_b64 exec, -1
s_branch L_qok
L_help:
s_add_u32 s53, s53, 1
s_cmp_ge_u32 s53, 131072
s_cbranch_scc1 L_end
v_readlane_b32 s43, v58, 16
s_nop 0
s_cmp_eq_u32 s43, 0
s_nop 1
s_cbranch_scc1 L_help2
s_bitcmp1_b32 s87, 1
s_cbranch_scc1 L_help1
s_or_b32 s87, s87, 2
s_lshr_b32 s43, s62, 4
s_lshl_b32 s43, s43, 2
v_mov_b32 v61, s43
v_mov_b32 v62, 1
s_mov_b64 exec, 1
buffer_atomic_add v62, v61, s[44:47], 0 offen offset:128
s_mov_b64 exec, -1
L_help1:
s_bitcmp1_b32 s87, 0
s_cbranch_scc0 L_help2
s_add_u32 s52, s60, 32
v_readlane_b32 s43, v58, s52
s_nop 0
s_cmp_lt_u32 s43, 16
s_nop 1
s_cbranch_scc1 L_help2
s_lshl_b32 s43, s60, 2
v_mov_b32 v61, s43
v_mov_b32 v62, 1
s_mov_b64 exec, 1
buffer_store_dword v62, v61, s[44:47], 0 offen sc1
s_mov_b64 exec, -1
L_help2:
s_sleep 32
s_branch L_apoll
.section .rodata,"a"
.p2align 6
.amdhsa_kernel parallel_sum__mha_block_cached__geglu_ffn__decode_kernel
  .amdhsa_next_free_vgpr 256
  .amdhsa_next_free_sgpr 96
  .amdhsa_accum_offset 256
  .amdhsa_group_segment_fixed_size 0
  .amdhsa_kernarg_size 96
  .amdhsa_user_sgpr_count 2
  .amdhsa_user_sgpr_kernarg_segment_ptr 1
  .amdhsa_system_sgpr_workgroup_id_x 1
.end_amdhsa_kernel
```
